```python
import torch

def _softmax(x, axis=-1):
    return torch.softmax(x, dim=axis)
def _gelu(x):
    return torch.nn.functional.gelu(x, approximate="tanh")
def _silu(x):
    return torch.nn.functional.silu(x)
def _sigmoid(x):
    return torch.sigmoid(x)
def _layernorm(x, axis=-1, eps=1e-5):
    m = x.mean(dim=axis, keepdim=True)
    v = x.var(dim=axis, keepdim=True, unbiased=False)
    return (x - m) / torch.sqrt(v + eps)
def _scatter_add(tgt, idx, src, axis=0):
    return tgt.clone().index_add_(axis, idx, src)
def _segment_sum(src, seg, n):
    out = torch.zeros((n,) + src.shape[1:], dtype=src.dtype)
    return out.index_add_(0, seg, src)
def _pad(x, pw):
    flat = tuple(v for pair in reversed(pw) for v in pair)
    return torch.nn.functional.pad(x, flat)

kernel_name = 'concat_heads__grouped_kv_mqa__linear_attn_block__prompt'

def setup_inputs():

    _w = (lambda a: (lambda t: t.to(torch.bfloat16) if t.is_floating_point() else t)(torch.as_tensor(a)))
    def _A_setup():
        B, S, D, H = 1, 2048, 512, 32
        Dh = D // H
        return {
            "x": _w((lambda *s: torch.randn(*s, dtype=torch.bfloat16) * 0.05)(B, S, D)),
            "wq": _w((lambda *s: torch.randn(*s, dtype=torch.bfloat16) * 1.6)(D, H * Dh)),
            "wk": _w((lambda *s: torch.randn(*s, dtype=torch.bfloat16) * 1.6)(D, Dh)),
            "wv": _w((lambda *s: torch.randn(*s, dtype=torch.bfloat16) * 0.05)(D, Dh)),
            "wo": _w((lambda *s: torch.randn(*s, dtype=torch.bfloat16) * 0.05)(H * Dh, D)),
        }
    _A_in = _A_setup()

    def _B_setup():
        B, S, D = 1, 2048, 512
        return {
            "x": _w((lambda *s: torch.randn(*s, dtype=torch.bfloat16) * 0.05)(B, S, D)),
            "wqkv": _w((lambda *s: torch.randn(*s, dtype=torch.bfloat16) * 0.8)(D, 3 * D)),
            "wo": _w((lambda *s: torch.randn(*s, dtype=torch.bfloat16) * 0.05)(D, D)),
        }
    _B_in = _B_setup()

    return {
        "A_x": _A_in["x"],
        "A_wq": _A_in["wq"],
        "A_wk": _A_in["wk"],
        "A_wv": _A_in["wv"],
        "A_wo": _A_in["wo"],
        "B_x": _B_in["x"],
        "B_wqkv": _B_in["wqkv"],
        "B_wo": _B_in["wo"],
    }

def reference(A_x, A_wq, A_wk, A_wv, A_wo, B_x, B_wqkv, B_wo):
    def _A_ref(x, wq, wk, wv, wo):
        B, S, D = x.shape
        H = 32
        Dh = D // H
        q = (lambda x, *d: x.permute(*d))((x @ wq).reshape(B, S, H, Dh), 0, 2, 1, 3)
        k = x @ wk
        v = x @ wv
        scores = torch.einsum("bhqd,bkd->bhqk", q, k) * (Dh ** -0.5)
        p = _softmax(scores, axis=-1)
        o = torch.einsum("bhqk,bkd->bhqd", p, v)
        return (lambda x, *d: x.permute(*d))(o, 0, 2, 1, 3).reshape(B, S, H * Dh) @ wo

    def _B_ref(x, wqkv, wo):
        B, S, D = x.shape
        H = 32; Dh = D // H
        qkv = (lambda x, *d: x.permute(*d))((x @ wqkv).reshape(B, S, 3, H, Dh), 2, 0, 3, 1, 4)
        q, k, v = qkv[0], qkv[1], qkv[2]
        phi = lambda t: torch.where(t > 0, t + 1, torch.exp(t)) + 1e-6
        pq, pk = phi(q), phi(k)
        kv = torch.einsum("bhsd,bhse->bhde", pk, v)
        z = torch.einsum("bhsd->bhd", pk)
        num = torch.einsum("bhqd,bhde->bhqe", pq, kv)
        den = torch.einsum("bhqd,bhd->bhq", pq, z)[..., None] + 1e-6
        o = num / den
        return (lambda x, *d: x.permute(*d))(o, 0, 2, 1, 3).reshape(B, S, D) @ wo

    a = _A_ref(A_x, A_wq, A_wk, A_wv, A_wo)
    b = _B_ref(B_x, B_wqkv, B_wo)
    return torch.concatenate([a, b], axis=-1)
```

```asm
; @launch grid=(256,1,1) block=(512,1,1) lds=163840
.amdgcn_target "amdgcn-amd-amdhsa--gfx950"
.text
.globl concat_heads__grouped_kv_mqa__linear_attn_block__prompt_kernel
.p2align 8
.type concat_heads__grouped_kv_mqa__linear_attn_block__prompt_kernel,@function
concat_heads__grouped_kv_mqa__linear_attn_block__prompt_kernel:
  s_cmp_ge_u32 s2, 256
  s_cbranch_scc1 L_exit
  s_lshr_b32 s5, s2, 5
  s_and_b32 s6, s5, 1
  s_lshl_b32 s6, s6, 3
  s_add_u32 s6, s6, 16
  s_load_dwordx2 s[8:9], s[0:1], 0
  s_load_dwordx2 s[16:17], s[0:1], s6
  s_load_dwordx2 s[12:13], s[0:1], 8
  s_load_dwordx2 s[44:45], s[0:1], 80
  v_lshrrev_b32 v15, 6, v0
  v_and_b32 v1, 63, v0
  v_readfirstlane_b32 s3, v15
  s_getpc_b64 s[48:49]
L_pc:
  s_mov_b32 s50, L_codeend - L_pc
  s_mov_b32 s51, 0x20000
  s_and_b32 s58, s2, -8
  s_lshl_b32 s58, s58, 5
  v_lshl_add_u32 v252, v1, 2, s58
  v_lshl_add_u32 v252, v15, 13, v252
  buffer_load_dword v247, v252, s[48:51], 0 offen
  s_sub_u32 s4, s2, 2
  s_and_b32 s4, s4, 7
  s_lshl_b32 s4, s4, 2
  s_bfe_u32 s55, s2, 0x20003
  s_add_u32 s4, s4, s55
  s_mov_b32 s11, 0x20000
  s_mov_b32 s10, 2097152
  s_mov_b32 s14, 524288
  s_mov_b32 s15, s11
  s_movk_i32 s18, 16384
  s_mov_b32 s19, s11
  s_mov_b32 s46, 6291456
  s_mov_b32 s47, s11
  v_lshlrev_b32 v2, 4, v1
  v_lshrrev_b32 v248, 3, v1
  v_and_b32 v249, 7, v1
  s_cmp_eq_u32 s3, 0
  s_cbranch_scc1 L_w0
  s_cmp_ge_u32 s3, 4
  s_cbranch_scc1 L_role1
  v_mov_b32 v210, 1073741824
  v_mov_b32 v211, v210
  v_mov_b32 v216, v210
  v_mov_b32 v217, v210
  v_mov_b32 v218, v210
  s_mov_b32 s65, 0
  s_waitcnt lgkmcnt(0)
  s_load_dword s40, s[44:45], 753664
  s_branch L_w123b
L_role1:
  s_sub_u32 s65, s3, 4
  s_lshl_b32 s66, s65, 10
  v_bfe_u32 v250, v1, 4, 1
  v_lshlrev_b32 v250, 2, v250
  v_xor_b32 v250, v250, v249
  v_lshlrev_b32 v250, 4, v250
  v_lshl_add_u32 v250, v248, 10, v250
  s_lshl_b32 s58, s65, 6
  s_add_u32 s58, s58, s5
  s_lshl_b32 s58, s58, 7
  v_add_u32 v209, s58, v250
  s_lshl_b32 s68, s4, 14
  s_cmp_ge_u32 s3, 6
  s_waitcnt lgkmcnt(0)
  s_load_dword s40, s[44:45], 753664
  s_cbranch_scc1 L_role1c
  buffer_load_dwordx4 v[144:147], v209, s[12:15], s68 offen
  s_branch L_role1c
L_w0:
  v_lshrrev_b32 v216, 1, v248
  v_xor_b32 v216, v216, v249
  v_lshlrev_b32 v216, 4, v216
  v_lshl_add_u32 v216, v248, 10, v216
  v_xor_b32 v217, 64, v216
  v_add_u32 v217, 7168, v217
  v_and_b32 v218, 16, v1
  v_lshlrev_b32 v218, 3, v218
  v_xor_b32 v218, v218, v2
  s_lshr_b32 s59, s5, 1
  s_lshl_b32 s58, s4, 2
  s_add_u32 s58, s58, s59
  v_and_b32 v253, 15, v1
  v_lshrrev_b32 v254, 4, v1
  v_and_b32 v255, 1, v254
  v_lshrrev_b32 v210, 5, v1
  s_lshr_b32 s65, s58, 1
  s_lshl_b32 s65, s65, 11
  s_and_b32 s66, s59, 1
  s_bitcmp1_b32 s5, 0
  s_cselect_b32 s67, 3, 9
  s_cselect_b32 s68, 8, 3
  s_cselect_b32 s69, 9, 8
  s_cselect_b32 s60, 2, 0
  v_lshlrev_b32 v210, s68, v210
  v_lshl_add_u32 v210, v255, s67, v210
  v_lshl_add_u32 v210, v253, 4, v210
  s_add_u32 s66, s66, s60
  s_lshl_b32 s66, s66, s69
  s_add_u32 s65, s65, s66
  s_cmp_lt_u32 s4, 8
  s_cselect_b32 s69, 0, 1073741824
  v_or_b32 v211, s69, v210
  v_mov_b32 v220, -1
  v_mov_b32 v221, -1
  s_lshl_b32 s41, s58, 14
  s_add_u32 s60, s59, s5
  s_lshl_b32 s60, s60, 2
  s_sub_u32 s66, s60, s55
  s_add_u32 s42, s60, s55
  s_lshl_b32 s67, s59, 11
  s_add_u32 s67, s67, 32768
  s_waitcnt lgkmcnt(0)
  s_load_dword s40, s[44:45], 753664
  buffer_store_dwordx2 v[220:221], v211, s[44:47], s65 offen sc1
  s_add_u32 s61, s42, 0
  s_and_b32 s61, s61, 7
  s_movk_i32 m0, 0
  s_lshl_b32 s61, s61, 11
  buffer_load_dwordx4 v218, s[16:19], s61 offen lds
  buffer_load_dwordx4 v218, s[16:19], s61 offen offset:1024 lds
  s_add_u32 s61, s42, 0
  s_and_b32 s61, s61, 7
  s_add_u32 s68, s66, 4
  s_and_b32 s68, s68, 7
  s_lshl_b32 s68, s68, 13
  s_add_u32 m0, s68, s67
  s_lshl_b32 s61, s61, 7
  s_add_u32 s61, s61, s41
  buffer_load_dwordx4 v216, s[8:11], s61 offen lds
  buffer_load_dwordx4 v217, s[8:11], s61 offen offset:1024 lds
  s_add_u32 s61, s42, 1
  s_and_b32 s61, s61, 7
  s_add_u32 s68, s66, 5
  s_and_b32 s68, s68, 7
  s_lshl_b32 s68, s68, 13
  s_add_u32 m0, s68, s67
  s_lshl_b32 s61, s61, 7
  s_add_u32 s61, s61, s41
  buffer_load_dwordx4 v216, s[8:11], s61 offen lds
  buffer_load_dwordx4 v217, s[8:11], s61 offen offset:1024 lds
  s_add_u32 s61, s42, 2
  s_and_b32 s61, s61, 7
  s_add_u32 s68, s66, 6
  s_and_b32 s68, s68, 7
  s_lshl_b32 s68, s68, 13
  s_add_u32 m0, s68, s67
  s_lshl_b32 s61, s61, 7
  s_add_u32 s61, s61, s41
  buffer_load_dwordx4 v216, s[8:11], s61 offen lds
  buffer_load_dwordx4 v217, s[8:11], s61 offen offset:1024 lds
  s_add_u32 s61, s42, 3
  s_and_b32 s61, s61, 7
  s_add_u32 s68, s66, 7
  s_and_b32 s68, s68, 7
  s_lshl_b32 s68, s68, 13
  s_add_u32 m0, s68, s67
  s_lshl_b32 s61, s61, 7
  s_add_u32 s61, s61, s41
  buffer_load_dwordx4 v216, s[8:11], s61 offen lds
  buffer_load_dwordx4 v217, s[8:11], s61 offen offset:1024 lds
  s_add_u32 s61, s42, 1
  s_and_b32 s61, s61, 7
  s_movk_i32 m0, 2048
  s_lshl_b32 s61, s61, 11
  buffer_load_dwordx4 v218, s[16:19], s61 offen lds
  buffer_load_dwordx4 v218, s[16:19], s61 offen offset:1024 lds
  s_add_u32 s61, s42, 2
  s_and_b32 s61, s61, 7
  s_movk_i32 m0, 4096
  s_lshl_b32 s61, s61, 11
  buffer_load_dwordx4 v218, s[16:19], s61 offen lds
  buffer_load_dwordx4 v218, s[16:19], s61 offen offset:1024 lds
  s_add_u32 s61, s42, 3
  s_and_b32 s61, s61, 7
  s_movk_i32 m0, 6144
  s_lshl_b32 s61, s61, 11
  buffer_load_dwordx4 v218, s[16:19], s61 offen lds
  buffer_load_dwordx4 v218, s[16:19], s61 offen offset:1024 lds
  s_add_u32 s61, s42, 4
  s_and_b32 s61, s61, 7
  s_add_u32 s68, s66, 8
  s_and_b32 s68, s68, 7
  s_lshl_b32 s68, s68, 13
  s_add_u32 m0, s68, s67
  s_lshl_b32 s61, s61, 7
  s_add_u32 s61, s61, s41
  buffer_load_dwordx4 v216, s[8:11], s61 offen lds
  buffer_load_dwordx4 v217, s[8:11], s61 offen offset:1024 lds
  s_add_u32 s61, s42, 4
  s_and_b32 s61, s61, 7
  s_movk_i32 m0, 8192
  s_lshl_b32 s61, s61, 11
  buffer_load_dwordx4 v218, s[16:19], s61 offen lds
  buffer_load_dwordx4 v218, s[16:19], s61 offen offset:1024 lds
  s_add_u32 s61, s42, 5
  s_and_b32 s61, s61, 7
  s_add_u32 s68, s66, 9
  s_and_b32 s68, s68, 7
  s_lshl_b32 s68, s68, 13
  s_add_u32 m0, s68, s67
  s_lshl_b32 s61, s61, 7
  s_add_u32 s61, s61, s41
  buffer_load_dwordx4 v216, s[8:11], s61 offen lds
  buffer_load_dwordx4 v217, s[8:11], s61 offen offset:1024 lds
  s_setprio 3
  v_lshl_add_u32 v208, v254, 1, v255
  v_lshlrev_b32 v208, 7, v208
  v_lshl_add_u32 v208, v253, 3, v208
  v_xor_b32 v209, 128, v208
  v_lshrrev_b32 v248, 1, v253
  v_xor_b32 v248, v248, v254
  v_lshlrev_b32 v248, 4, v248
  v_lshl_add_u32 v248, v253, 7, v248
  s_add_u32 s68, s66, 4
  s_and_b32 s68, s68, 7
  s_lshl_b32 s68, s68, 13
  s_add_u32 s68, s68, s67
  v_add_u32 v80, s68, v248
  v_xor_b32 v81, 64, v80
  s_add_u32 s68, s66, 5
  s_and_b32 s68, s68, 7
  s_lshl_b32 s68, s68, 13
  s_add_u32 s68, s68, s67
  v_add_u32 v82, s68, v248
  v_xor_b32 v83, 64, v82
  s_add_u32 s68, s66, 6
  s_and_b32 s68, s68, 7
  s_lshl_b32 s68, s68, 13
  s_add_u32 s68, s68, s67
  v_add_u32 v84, s68, v248
  v_xor_b32 v85, 64, v84
  s_add_u32 s68, s66, 7
  s_and_b32 s68, s68, 7
  s_lshl_b32 s68, s68, 13
  s_add_u32 s68, s68, s67
  v_add_u32 v86, s68, v248
  v_xor_b32 v87, 64, v86
  s_add_u32 s68, s66, 8
  s_and_b32 s68, s68, 7
  s_lshl_b32 s68, s68, 13
  s_add_u32 s68, s68, s67
  v_add_u32 v88, s68, v248
  v_xor_b32 v89, 64, v88
  s_add_u32 s68, s66, 9
  s_and_b32 s68, s68, 7
  s_lshl_b32 s68, s68, 13
  s_add_u32 s68, s68, s67
  v_add_u32 v90, s68, v248
  v_xor_b32 v91, 64, v90
  s_add_u32 s68, s66, 10
  s_and_b32 s68, s68, 7
  s_lshl_b32 s68, s68, 13
  s_add_u32 s68, s68, s67
  v_add_u32 v92, s68, v248
  v_xor_b32 v93, 64, v92
  s_add_u32 s68, s66, 11
  s_and_b32 s68, s68, 7
  s_lshl_b32 s68, s68, 13
  s_add_u32 s68, s68, s67
  v_add_u32 v94, s68, v248
  v_xor_b32 v95, 64, v94
L_w123b:
  s_load_dwordx2 s[20:21], s[0:1], 32
  s_load_dwordx2 s[24:25], s[0:1], 40
  s_load_dwordx2 s[28:29], s[0:1], 48
  s_load_dwordx2 s[32:33], s[0:1], 56
  s_load_dwordx2 s[36:37], s[0:1], 64
  s_mov_b32 s22, 524288
  s_mov_b32 s23, s11
  s_mov_b32 s26, 2097152
  s_mov_b32 s27, s11
  s_mov_b32 s30, 1572864
  s_mov_b32 s31, s11
  s_mov_b32 s34, 524288
  s_mov_b32 s35, s11
  s_mov_b32 s38, 4194304
  s_mov_b32 s39, s11
  s_lshl_b32 s57, s3, 10
  s_mov_b32 s52, 0x0000ffff
  s_mov_b32 s53, 0x0000ffff
  v_mov_b32 v5, 0xdddd
  s_getreg_b32 s71, hwreg(HW_REG_XCC_ID, 0, 4)
  s_and_b32 s62, s3, 1
  s_bfe_u32 s63, s3, 0x10001
  s_lshl_b32 s64, s5, 2
  s_lshl_b32 s58, s63, 1
  s_add_u32 s64, s64, s58
  v_lshrrev_b32 v248, 5, v1
  v_and_b32 v249, 31, v1
  v_and_b32 v250, 15, v1
  s_cmp_eq_u32 s3, 0
  s_cselect_b32 s58, 0, 1073741824
  v_lshlrev_b32 v3, 30, v248
  v_lshl_or_b32 v3, v249, 2, v3
  v_or_b32 v3, s58, v3
  s_lshl_b32 s70, s4, 3
  s_add_u32 s70, s70, s5
  s_lshl_b32 s70, s70, 7
  s_add_u32 s70, s70, 655360
  v_bfe_u32 v251, v1, 1, 3
  v_xor_b32 v251, v251, v248
  v_lshlrev_b32 v251, 4, v251
  v_lshl_add_u32 v251, v249, 7, v251
  s_lshl_b32 s58, s62, 12
  s_add_u32 s58, s58, 32768
  v_add_u32 v224, s58, v251
  v_xor_b32 v225, 32, v224
  v_xor_b32 v226, 64, v224
  v_xor_b32 v227, 96, v224
  v_bfe_u32 v252, v1, 2, 2
  v_bfe_u32 v253, v1, 4, 1
  v_lshlrev_b32 v253, 1, v253
  v_bfe_u32 v254, v1, 1, 1
  v_or_b32 v253, v253, v254
  v_bfe_u32 v254, v1, 3, 1
  v_lshl_or_b32 v253, v254, 2, v253
  v_lshlrev_b32 v253, 4, v253
  v_and_b32 v254, 1, v1
  v_lshl_or_b32 v253, v254, 3, v253
  v_lshl_add_u32 v254, v248, 3, v252
  v_lshl_add_u32 v253, v254, 7, v253
  v_add_u32 v253, 98304, v253
  s_lshl_b32 s58, s63, 6
  v_xor_b32 v8, s58, v253
  v_mov_b32 v9, v253
  s_lshl_b32 s58, s3, 11
  s_add_u32 s58, s58, 49152
  v_add_u32 v240, s58, v2
  v_xor_b32 v241, 8192, v240
  s_waitcnt lgkmcnt(0)
  s_add_u32 s40, s40, 0x9e3779b0
  s_and_b32 s40, s40, -16
  v_mov_b32 v4, s40
  s_cmp_lg_u32 s3, 0
  s_cbranch_scc1 L_bar0
  s_add_u32 s58, s70, 32768
  v_or_b32 v220, s69, v3
  s_waitcnt vmcnt(22)
  buffer_store_dword v4, v220, s[44:47], s58 offen sc1
  s_add_u32 s61, s42, 5
  s_and_b32 s61, s61, 7
  s_movk_i32 m0, 10240
  s_lshl_b32 s61, s61, 11
  buffer_load_dwordx4 v218, s[16:19], s61 offen lds
  buffer_load_dwordx4 v218, s[16:19], s61 offen offset:1024 lds
  s_add_u32 s61, s42, 6
  s_and_b32 s61, s61, 7
  s_add_u32 s68, s66, 10
  s_and_b32 s68, s68, 7
  s_lshl_b32 s68, s68, 13
  s_add_u32 m0, s68, s67
  s_lshl_b32 s61, s61, 7
  s_add_u32 s61, s61, s41
  buffer_load_dwordx4 v216, s[8:11], s61 offen lds
  buffer_load_dwordx4 v217, s[8:11], s61 offen offset:1024 lds
  s_add_u32 s61, s42, 6
  s_and_b32 s61, s61, 7
  s_movk_i32 m0, 12288
  s_lshl_b32 s61, s61, 11
  buffer_load_dwordx4 v218, s[16:19], s61 offen lds
  buffer_load_dwordx4 v218, s[16:19], s61 offen offset:1024 lds
  s_add_u32 s61, s42, 7
  s_and_b32 s61, s61, 7
  s_add_u32 s68, s66, 11
  s_and_b32 s68, s68, 7
  s_lshl_b32 s68, s68, 13
  s_add_u32 m0, s68, s67
  s_lshl_b32 s61, s61, 7
  s_add_u32 s61, s61, s41
  buffer_load_dwordx4 v216, s[8:11], s61 offen lds
  buffer_load_dwordx4 v217, s[8:11], s61 offen offset:1024 lds
  s_add_u32 s61, s42, 7
  s_and_b32 s61, s61, 7
  s_movk_i32 m0, 14336
  s_lshl_b32 s61, s61, 11
  buffer_load_dwordx4 v218, s[16:19], s61 offen lds
  buffer_load_dwordx4 v218, s[16:19], s61 offen offset:1024 lds
L_bar0:
  s_barrier
  s_cmp_eq_u32 s3, 0
  s_cbranch_scc1 L_padret
  s_mov_b64 exec, 0
  s_cmp_eq_u32 s3, 2
  s_cbranch_scc1 L_isV
  s_cmp_eq_u32 s3, 3
  s_cbranch_scc1 L_role1b
  s_branch L_kv
L_padret:
  s_mov_b64 exec, -1
  s_lshl_b32 s58, s63, 13
  v_add_u32 v228, s58, v224
  v_add_u32 v229, s58, v225
  v_add_u32 v230, s58, v226
  v_add_u32 v231, s58, v227
  v_mov_b32 v6, v2
  v_lshl_add_u32 v251, v248, 4, v250
  v_lshlrev_b32 v251, 4, v251
  v_add_u32 v7, 1024, v251
  v_lshrrev_b32 v252, 3, v1
  v_and_b32 v253, 7, v1
  s_lshl_b32 s59, s3, 3
  v_add_u32 v254, s59, v252
  v_bfe_u32 v255, v254, 1, 3
  v_xor_b32 v255, v255, v253
  v_lshlrev_b32 v255, 4, v255
  v_lshl_add_u32 v255, v254, 10, v255
  s_lshr_b32 s58, s4, 1
  s_lshl_b32 s58, s58, 17
  v_add_u32 v10, s58, v255
  v_bfe_u32 v255, v1, 4, 1
  v_lshlrev_b32 v255, 2, v255
  v_xor_b32 v255, v255, v253
  v_mul_u32_u24 v11, 3072, v254
  s_lshl_b32 s60, s5, 7
  v_add_u32 v11, s60, v11
  v_lshrrev_b32 v12, 2, v255
  v_lshl_add_u32 v12, v12, 10, v11
  v_and_b32 v15, 3, v255
  v_lshl_add_u32 v12, v15, 4, v12
  s_and_b32 s58, s4, 1
  s_lshl_b32 s56, s58, 13
  s_lshl_b32 s58, s58, 6
  s_add_u32 s58, s58, 1024
  v_add_u32 v12, s58, v12
  v_lshl_add_u32 v11, v255, 4, v11
  v_bfe_u32 v255, v1, 4, 2
  v_lshlrev_b32 v255, 1, v255
  v_xor_b32 v255, v255, v253
  v_lshlrev_b32 v255, 4, v255
  v_lshl_add_u32 v255, v254, 10, v255
  v_add_u32 v13, s60, v255
  v_add_u32 v14, s57, v2
  v_bfe_u32 v251, v1, 2, 3
  v_lshl_add_u32 v254, v248, 4, v251
  v_and_b32 v251, 6, v251
  v_bfe_u32 v255, v1, 1, 1
  v_or_b32 v251, v251, v255
  v_lshlrev_b32 v251, 4, v251
  v_and_b32 v255, 1, v1
  v_lshl_or_b32 v251, v255, 3, v251
  v_lshl_add_u32 v251, v254, 7, v251
  v_add_u32 v232, 32768, v251
  v_xor_b32 v233, 32, v232
  v_xor_b32 v234, 64, v232
  v_xor_b32 v235, 96, v232
  v_bfe_u32 v251, v1, 4, 1
  v_lshlrev_b32 v251, 14, v251
  v_lshl_add_u32 v251, v248, 8, v251
  v_lshl_add_u32 v251, v250, 4, v251
  s_lshl_b32 s58, s4, 16
  s_lshl_b32 s59, s62, 15
  s_add_u32 s59, s59, s58
  s_lshl_b32 s61, s64, 9
  s_add_u32 s59, s59, s61
  v_add_u32 v236, s59, v251
  s_and_b32 s59, s3, 3
  s_lshl_b32 s77, s59, 14
  s_add_u32 s77, s77, s58
  s_add_u32 s77, s77, 3145728
  s_lshl_b32 s58, s4, 17
  s_lshl_b32 s59, s59, 15
  s_add_u32 s58, s58, s59
  s_add_u32 s58, s58, s60
  s_add_u32 s58, s58, 1024
  v_bfe_u32 v251, v1, 4, 1
  v_lshlrev_b32 v251, 5, v251
  v_lshl_add_u32 v251, v248, 4, v251
  v_lshl_add_u32 v251, v250, 11, v251
  v_add_u32 v237, s58, v251
  s_mul_i32 s58, s3, 3072
  v_add_u32 v242, s58, v2
  v_add_u32 v243, 12288, v242
  s_lshl_b32 s58, s62, 8
  v_xor_b32 v238, s58, v2
  v_add_u32 v238, 65536, v238
  v_add_u32 v239, 8192, v238
  s_and_b32 s58, s4, 1
  s_lshl_b32 s58, s58, 1
  s_lshl_b32 s59, s5, 2
  s_add_u32 s58, s58, s59
  s_add_u32 s58, s58, s62
  s_lshl_b32 s58, s58, 4
  s_lshr_b32 s59, s4, 1
  s_add_u32 s58, s58, s59
  s_lshl_b32 s74, s58, 10
  s_add_u32 s74, s74, 131072
  s_cmp_ge_u32 s3, 2
  s_cselect_b32 s58, 1073741824, 0
  v_or_b32 v245, s58, v2
  s_lshr_b32 s58, s4, 2
  s_lshl_b32 s58, s58, 5
  s_add_u32 s75, s58, s64
  s_lshl_b32 s75, s75, 12
  s_add_u32 s75, s75, 5242880
  v_mov_b32 v136, -1
  v_mov_b32 v137, -1
  v_mov_b32 v138, -1
  v_mov_b32 v139, -1
  s_lshl_b32 s58, s4, 3
  v_and_or_b32 v246, v1, 7, s58
  s_and_b32 s58, s58, -32
  s_add_u32 s58, s58, s5
  v_and_b32 v251, 3, v1
  v_lshl_add_u32 v251, v251, 3, s58
  v_cmp_gt_u32 vcc, 8, v1
  s_mov_b32 s58, 655360
  s_nop 0
  v_cndmask_b32 v246, v251, v246, vcc
  v_lshl_add_u32 v246, v246, 7, s58
  v_lshl_add_u32 v251, v249, 3, s5
  s_lshl_b32 s58, s4, 3
  v_and_or_b32 v252, v1, 7, s58
  v_cmp_gt_u32 vcc, 32, v1
  s_lshl_b32 s54, s3, 13
  v_lshlrev_b32 v244, 7, v1
  v_add_u32 v244, 655360, v244
  v_cndmask_b32 v140, v252, v251, vcc
  v_lshlrev_b32 v140, 7, v140
  v_add_u32 v140, 720896, v140
  s_cmp_eq_u32 s3, 0
  s_cbranch_scc1 L_kv
  s_branch L_main0

.p2align 12
L_role1c:
  s_and_b32 s59, s65, 1
  s_lshl_b32 s60, s59, 2
  v_lshrrev_b32 v250, 1, v248
  v_xor_b32 v250, v250, v249
  v_xor_b32 v250, s60, v250
  v_lshlrev_b32 v250, 4, v250
  v_lshl_add_u32 v250, v248, 10, v250
  s_lshl_b32 s58, s4, 16
  v_add_u32 v208, s58, v250
  s_and_b32 s58, s5, 6
  s_add_u32 s48, s58, s65
  s_add_u32 s48, s48, 2
  s_and_b32 s48, s48, 7
  s_add_u32 s49, s58, s59
  s_add_u32 s49, s49, 6
  s_and_b32 s49, s49, 7
  s_lshl_b32 s51, s48, 13
  s_lshl_b32 s54, s49, 13
  s_lshl_b32 s48, s48, 10
  s_lshr_b32 s70, s65, 1
  s_lshl_b32 s58, s70, 3
  s_add_u32 s49, s49, s58
  s_lshl_b32 s49, s49, 10
  s_lshl_b32 s69, s55, 1
  s_add_u32 s70, s70, s69
  s_load_dwordx2 s[20:21], s[0:1], 32
  s_load_dwordx2 s[24:25], s[0:1], 40
  s_load_dwordx2 s[28:29], s[0:1], 48
  s_load_dwordx2 s[32:33], s[0:1], 56
  s_load_dwordx2 s[36:37], s[0:1], 64
  s_mov_b32 s22, 524288
  s_mov_b32 s23, s11
  s_mov_b32 s26, 2097152
  s_mov_b32 s27, s11
  s_mov_b32 s30, 1572864
  s_mov_b32 s31, s11
  s_mov_b32 s34, 524288
  s_mov_b32 s35, s11
  s_mov_b32 s38, 4194304
  s_mov_b32 s39, s11
  s_lshl_b32 s57, s3, 10
  s_mov_b32 s52, 0x0000ffff
  s_mov_b32 s53, 0x0000ffff
  v_mov_b32 v5, 0xdddd
  s_getreg_b32 s71, hwreg(HW_REG_XCC_ID, 0, 4)
  s_and_b32 s62, s3, 1
  s_bfe_u32 s63, s3, 0x10001
  s_lshl_b32 s64, s5, 2
  s_lshl_b32 s58, s63, 1
  s_add_u32 s64, s64, s58
  s_add_u32 s64, s64, 1
  v_lshrrev_b32 v248, 5, v1
  v_and_b32 v249, 31, v1
  v_and_b32 v250, 15, v1
  v_bfe_u32 v251, v1, 1, 3
  v_xor_b32 v251, v251, v248
  v_lshlrev_b32 v251, 4, v251
  v_lshl_add_u32 v251, v249, 7, v251
  s_lshl_b32 s58, s62, 12
  s_add_u32 s58, s58, 32768
  v_add_u32 v224, s58, v251
  v_xor_b32 v225, 32, v224
  v_xor_b32 v226, 64, v224
  v_xor_b32 v227, 96, v224
  v_bfe_u32 v252, v1, 2, 2
  v_bfe_u32 v253, v1, 4, 1
  v_lshlrev_b32 v253, 1, v253
  v_bfe_u32 v254, v1, 1, 1
  v_or_b32 v253, v253, v254
  v_bfe_u32 v254, v1, 3, 1
  v_lshl_or_b32 v253, v254, 2, v253
  v_lshlrev_b32 v253, 4, v253
  v_and_b32 v254, 1, v1
  v_lshl_or_b32 v253, v254, 3, v253
  v_lshl_add_u32 v254, v248, 3, v252
  v_lshl_add_u32 v253, v254, 7, v253
  v_add_u32 v253, 98304, v253
  s_lshl_b32 s58, s63, 6
  v_xor_b32 v8, s58, v253
  v_xor_b32 v9, 64, v253
  s_lshl_b32 s58, s3, 11
  s_add_u32 s58, s58, 49152
  v_add_u32 v240, s58, v2
  v_xor_b32 v241, 8192, v240
  s_waitcnt lgkmcnt(0)
  s_add_u32 s40, s40, 0x9e3779b0
  s_and_b32 s40, s40, -16
  v_mov_b32 v4, s40
  v_bfe_u32 v210, v1, 2, 2
  v_and_b32 v251, 3, v1
  v_lshl_add_u32 v210, v210, 4, v251
  s_lshr_b32 s58, s66, 1
  s_add_u32 s58, s58, 688128
  v_lshl_add_u32 v210, v210, 7, s58
  s_lshl_b32 s58, s63, 13
  v_add_u32 v228, s58, v224
  v_add_u32 v229, s58, v225
  v_add_u32 v230, s58, v226
  v_add_u32 v231, s58, v227
  v_add_u32 v6, 2048, v2
  v_lshl_add_u32 v251, v248, 4, v250
  v_lshlrev_b32 v251, 4, v251
  v_add_u32 v7, 3072, v251
  v_lshrrev_b32 v252, 3, v1
  v_and_b32 v253, 7, v1
  s_lshl_b32 s59, s3, 3
  v_add_u32 v254, s59, v252
  v_bfe_u32 v255, v254, 1, 3
  v_xor_b32 v255, v255, v253
  v_lshlrev_b32 v255, 4, v255
  v_lshl_add_u32 v255, v254, 10, v255
  s_lshr_b32 s58, s4, 1
  s_lshl_b32 s58, s58, 17
  v_add_u32 v10, s58, v255
  v_bfe_u32 v255, v1, 4, 1
  v_lshlrev_b32 v255, 2, v255
  v_xor_b32 v255, v255, v253
  v_mul_u32_u24 v11, 3072, v254
  s_lshl_b32 s60, s5, 7
  v_add_u32 v11, s60, v11
  v_lshrrev_b32 v12, 2, v255
  v_lshl_add_u32 v12, v12, 10, v11
  v_and_b32 v15, 3, v255
  v_lshl_add_u32 v12, v15, 4, v12
  s_and_b32 s58, s4, 1
  s_barrier
  s_add_u32 s67, s69, 0
  s_and_b32 s67, s67, 7
  s_add_u32 m0, s66, 131072
  s_lshl_b32 s68, s67, 16
  buffer_load_dwordx4 v209, s[12:15], s68 offen lds
  s_lshl_b32 s56, s58, 13
  s_lshl_b32 s58, s58, 6
  s_add_u32 s58, s58, 1024
  v_add_u32 v12, s58, v12
  v_lshl_add_u32 v11, v255, 4, v11
  v_bfe_u32 v255, v1, 4, 2
  v_lshlrev_b32 v255, 1, v255
  v_xor_b32 v255, v255, v253
  s_add_u32 m0, s66, 135168
  s_add_u32 s68, s68, 32768
  buffer_load_dwordx4 v209, s[12:15], s68 offen lds
  v_lshlrev_b32 v255, 4, v255
  v_lshl_add_u32 v255, v254, 10, v255
  v_add_u32 v13, s60, v255
  v_add_u32 v14, s57, v2
  v_bfe_u32 v251, v1, 2, 3
  v_lshl_add_u32 v254, v248, 4, v251
  v_and_b32 v251, 6, v251
  v_bfe_u32 v255, v1, 1, 1
  s_add_u32 s67, s69, 1
  s_and_b32 s67, s67, 7
  s_add_u32 m0, s66, 139264
  s_lshl_b32 s68, s67, 16
  buffer_load_dwordx4 v209, s[12:15], s68 offen lds
  v_or_b32 v251, v251, v255
  v_lshlrev_b32 v251, 4, v251
  v_and_b32 v255, 1, v1
  v_lshl_or_b32 v251, v255, 3, v251
  v_lshl_add_u32 v251, v254, 7, v251
  v_add_u32 v232, 98304, v251
  v_xor_b32 v233, 32, v232
  v_xor_b32 v234, 64, v232
  s_add_u32 m0, s66, 143360
  s_add_u32 s68, s68, 32768
  buffer_load_dwordx4 v209, s[12:15], s68 offen lds
  v_xor_b32 v235, 96, v232
  v_bfe_u32 v251, v1, 4, 1
  v_lshlrev_b32 v251, 14, v251
  v_lshl_add_u32 v251, v248, 8, v251
  v_lshl_add_u32 v251, v250, 4, v251
  s_lshl_b32 s58, s4, 16
  s_lshl_b32 s59, s62, 15
  s_add_u32 s59, s59, s58
  s_add_u32 s67, s69, 0
  s_and_b32 s67, s67, 7
  s_add_u32 m0, s48, 65536
  s_lshl_b32 s67, s67, 7
  s_add_u32 s67, s67, s51
  buffer_load_dwordx4 v208, s[8:11], s67 offen lds
  s_lshl_b32 s61, s64, 9
  s_add_u32 s59, s59, s61
  v_add_u32 v236, s59, v251
  s_and_b32 s59, s3, 3
  s_lshl_b32 s77, s59, 14
  s_add_u32 s77, s77, s58
  s_add_u32 s77, s77, 1048576
  s_lshl_b32 s58, s4, 17
  s_add_u32 s67, s70, 0
  s_and_b32 s67, s67, 7
  s_add_u32 m0, s49, 65536
  s_lshl_b32 s67, s67, 7
  s_add_u32 s67, s67, s54
  buffer_load_dwordx4 v208, s[8:11], s67 offen lds
  s_lshl_b32 s59, s59, 15
  s_add_u32 s58, s58, s59
  s_add_u32 s58, s58, s60
  v_bfe_u32 v251, v1, 4, 1
  v_lshlrev_b32 v251, 5, v251
  v_lshl_add_u32 v251, v248, 4, v251
  v_lshl_add_u32 v251, v250, 11, v251
  v_add_u32 v237, s58, v251
  s_add_u32 s67, s69, 1
  s_and_b32 s67, s67, 7
  s_add_u32 m0, s48, 73728
  s_lshl_b32 s67, s67, 7
  s_add_u32 s67, s67, s51
  buffer_load_dwordx4 v208, s[8:11], s67 offen lds
  s_mul_i32 s58, s3, 3072
  v_add_u32 v242, s58, v2
  v_subrev_u32 v243, 12288, v242
  s_lshr_b32 s58, s4, 2
  s_lshl_b32 s58, s58, 5
  s_add_u32 s75, s58, s64
  s_lshl_b32 s75, s75, 12
  s_add_u32 s75, s75, 5242880
  s_add_u32 s67, s69, 2
  s_and_b32 s67, s67, 7
  s_add_u32 m0, s66, 147456
  s_lshl_b32 s68, s67, 16
  buffer_load_dwordx4 v209, s[12:15], s68 offen lds
  s_lshl_b32 s59, s5, 2
  s_add_u32 s59, s59, s55
  s_lshl_b32 s61, s59, 2
  s_add_u32 s61, s61, s3
  s_sub_u32 s61, s61, 4
  s_lshl_b32 s73, s61, 12
  s_add_u32 s73, s73, 131072
  s_lshl_b32 s58, s58, 2
  s_add_u32 s67, s69, 2
  s_and_b32 s67, s67, 7
  s_add_u32 m0, s48, 81920
  s_lshl_b32 s67, s67, 7
  s_add_u32 s67, s67, s51
  buffer_load_dwordx4 v208, s[8:11], s67 offen lds
  s_add_u32 s50, s58, s61
  s_lshl_b32 s50, s50, 10
  s_add_u32 s50, s50, 5242880
  v_lshlrev_b32 v251, 2, v248
  v_sub_u32 v251, v249, v251
  v_mov_b32 v252, 0x3f80
  v_mov_b32 v253, 0x3f800000
  v_cmp_eq_u32 vcc, 0, v251
  v_cmp_eq_u32 s[78:79], 1, v251
  s_nop 0
  v_cndmask_b32 v192, 0, v252, vcc
  s_add_u32 m0, s66, 151552
  s_add_u32 s68, s68, 32768
  buffer_load_dwordx4 v209, s[12:15], s68 offen lds
  v_cndmask_b32 v192, v192, v253, s[78:79]
  v_cmp_eq_u32 vcc, 2, v251
  v_cmp_eq_u32 s[78:79], 3, v251
  s_nop 0
  v_cndmask_b32 v193, 0, v252, vcc
  v_cndmask_b32 v193, v193, v253, s[78:79]
  v_cmp_eq_u32 vcc, 8, v251
  v_cmp_eq_u32 s[78:79], 9, v251
  s_nop 0
  v_cndmask_b32 v194, 0, v252, vcc
  s_add_u32 s67, s70, 2
  s_and_b32 s67, s67, 7
  s_add_u32 m0, s49, 81920
  s_lshl_b32 s67, s67, 7
  s_add_u32 s67, s67, s54
  buffer_load_dwordx4 v208, s[8:11], s67 offen lds
  v_cndmask_b32 v194, v194, v253, s[78:79]
  v_cmp_eq_u32 vcc, 10, v251
  v_cmp_eq_u32 s[78:79], 11, v251
  s_nop 0
  v_cndmask_b32 v195, 0, v252, vcc
  v_cndmask_b32 v195, v195, v253, s[78:79]
  v_mov_b32 v136, -1
  v_mov_b32 v137, -1
  s_add_u32 s67, s69, 3
  s_and_b32 s67, s67, 7
  s_add_u32 m0, s66, 155648
  s_lshl_b32 s68, s67, 16
  buffer_load_dwordx4 v209, s[12:15], s68 offen lds
  v_mov_b32 v138, -1
  v_mov_b32 v139, -1
  s_lshl_b32 s58, s4, 3
  v_and_or_b32 v246, v1, 7, s58
  s_and_b32 s58, s58, -32
  s_add_u32 s58, s58, s5
  v_and_b32 v251, 3, v1
  v_lshl_add_u32 v251, v251, 3, s58
  s_waitcnt vmcnt(12)
  buffer_load_dword v247, v210, s[44:47], 0 offen sc1
  s_add_u32 s67, s69, 3
  s_and_b32 s67, s67, 7
  s_add_u32 m0, s48, 90112
  s_lshl_b32 s67, s67, 7
  s_add_u32 s67, s67, s51
  buffer_load_dwordx4 v208, s[8:11], s67 offen lds
  v_cmp_gt_u32 vcc, 8, v1
  s_mov_b32 s58, 655360
  s_nop 0
  v_cndmask_b32 v246, v251, v246, vcc
  v_lshl_add_u32 v246, v246, 7, s58
  v_and_b32 v251, 27, v1
  v_cmp_eq_u32 vcc, 16, v251
  v_mov_b32 v252, 0x3f803f80
  v_mov_b32 v253, 0
  v_cndmask_b32 v96, v253, v252, vcc
  s_add_u32 m0, s66, 159744
  s_add_u32 s68, s68, 32768
  buffer_load_dwordx4 v209, s[12:15], s68 offen lds
  v_mov_b32 v97, v96
  v_mov_b32 v98, v96
  v_mov_b32 v99, v96
  v_mov_b32 v104, v96
  v_mov_b32 v105, v96
  v_mov_b32 v106, v96
  v_mov_b32 v107, v96
  v_mov_b32 v100, v96
  s_add_u32 s67, s69, 4
  s_and_b32 s67, s67, 7
  s_add_u32 m0, s66, 98304
  s_lshl_b32 s68, s67, 16
  buffer_load_dwordx4 v209, s[12:15], s68 offen lds
  v_mov_b32 v101, v96
  v_mov_b32 v102, v96
  v_mov_b32 v103, v96
  v_mov_b32 v108, v96
  v_mov_b32 v109, v96
  v_mov_b32 v110, v96
  v_mov_b32 v111, v96
  v_mov_b32 v48, 0
  s_add_u32 s67, s69, 4
  s_and_b32 s67, s67, 7
  s_add_u32 m0, s48, 32768
  s_lshl_b32 s67, s67, 7
  s_add_u32 s67, s67, s51
  buffer_load_dwordx4 v208, s[8:11], s67 offen lds
  v_mov_b32 v49, 0
  v_mov_b32 v50, 0
  v_mov_b32 v51, 0
  v_mov_b32 v52, 0
  v_mov_b32 v53, 0
  v_mov_b32 v54, 0
  v_mov_b32 v55, 0
  v_mov_b32 v56, 0
  s_add_u32 m0, s66, 102400
  s_add_u32 s68, s68, 32768
  buffer_load_dwordx4 v209, s[12:15], s68 offen lds
  v_mov_b32 v57, 0
  v_mov_b32 v58, 0
  v_mov_b32 v59, 0
  v_mov_b32 v60, 0
  v_mov_b32 v61, 0
  v_mov_b32 v62, 0
  v_mov_b32 v63, 0
  v_mov_b32 v64, 0
  s_waitcnt vmcnt(11)
  s_barrier
  s_add_u32 s67, s70, 4
  s_and_b32 s67, s67, 7
  s_add_u32 m0, s49, 32768
  s_lshl_b32 s67, s67, 7
  s_add_u32 s67, s67, s54
  buffer_load_dwordx4 v208, s[8:11], s67 offen lds
  v_mov_b32 v65, 0
  v_mov_b32 v66, 0
  v_mov_b32 v67, 0
  v_mov_b32 v68, 0
  v_mov_b32 v69, 0
  v_mov_b32 v70, 0
  v_mov_b32 v71, 0
  v_mov_b32 v72, 0
  s_add_u32 s67, s69, 5
  s_and_b32 s67, s67, 7
  s_add_u32 m0, s66, 106496
  s_lshl_b32 s68, s67, 16
  buffer_load_dwordx4 v209, s[12:15], s68 offen lds
  v_mov_b32 v73, 0
  v_mov_b32 v74, 0
  v_mov_b32 v75, 0
  v_mov_b32 v76, 0
  v_mov_b32 v77, 0
  v_mov_b32 v78, 0
  v_mov_b32 v79, 0
  s_add_u32 s67, s69, 5
  s_and_b32 s67, s67, 7
  s_add_u32 m0, s48, 40960
  s_lshl_b32 s67, s67, 7
  s_add_u32 s67, s67, s51
  buffer_load_dwordx4 v208, s[8:11], s67 offen lds
  s_add_u32 m0, s66, 110592
  s_add_u32 s68, s68, 32768
  buffer_load_dwordx4 v209, s[12:15], s68 offen lds
  s_add_u32 s67, s69, 6
  s_and_b32 s67, s67, 7
  s_add_u32 m0, s66, 114688
  s_lshl_b32 s68, s67, 16
  buffer_load_dwordx4 v209, s[12:15], s68 offen lds
  s_add_u32 s67, s69, 6
  s_and_b32 s67, s67, 7
  s_add_u32 m0, s48, 49152
  s_lshl_b32 s67, s67, 7
  s_add_u32 s67, s67, s51
  buffer_load_dwordx4 v208, s[8:11], s67 offen lds
  s_add_u32 m0, s66, 118784
  s_add_u32 s68, s68, 32768
  buffer_load_dwordx4 v209, s[12:15], s68 offen lds
  s_waitcnt vmcnt(10)
  s_barrier
  s_add_u32 s67, s70, 6
  s_and_b32 s67, s67, 7
  s_add_u32 m0, s49, 49152
  s_lshl_b32 s67, s67, 7
  s_add_u32 s67, s67, s54
  buffer_load_dwordx4 v208, s[8:11], s67 offen lds
  s_add_u32 s67, s69, 7
  s_and_b32 s67, s67, 7
  s_add_u32 m0, s66, 122880
  s_lshl_b32 s68, s67, 16
  buffer_load_dwordx4 v209, s[12:15], s68 offen lds
  s_add_u32 s67, s69, 7
  s_and_b32 s67, s67, 7
  s_add_u32 m0, s48, 57344
  s_lshl_b32 s67, s67, 7
  s_add_u32 s67, s67, s51
  buffer_load_dwordx4 v208, s[8:11], s67 offen lds
  s_add_u32 m0, s66, 126976
  s_add_u32 s68, s68, 32768
  buffer_load_dwordx4 v209, s[12:15], s68 offen lds
  s_waitcnt vmcnt(7)
  s_barrier
  v_xor_b32 v247, v247, v4
  v_cmp_lt_u32 vcc, 15, v247
  s_nop 0
  s_cbranch_vccnz L_spin_p1a
L_back_p1a:
  s_lshl_b32 s48, s66, 1
  v_add_u32 v210, s48, v2
  s_add_u32 m0, s48, 0
  s_add_u32 s67, s48, 0
  buffer_load_dwordx4 v2, s[44:47], s67 offen sc1 lds
  buffer_load_dwordx4 v2, s[44:47], s67 offen offset:1024 sc1 lds
  s_add_u32 m0, s48, 8192
  s_add_u32 s67, s48, 8192
  buffer_load_dwordx4 v2, s[44:47], s67 offen sc1 lds
  buffer_load_dwordx4 v2, s[44:47], s67 offen offset:1024 sc1 lds
  s_waitcnt vmcnt(4)
  s_barrier
  s_add_u32 m0, s48, 16384
  s_add_u32 s67, s48, 16384
  buffer_load_dwordx4 v2, s[44:47], s67 offen sc1 lds
  buffer_load_dwordx4 v2, s[44:47], s67 offen offset:1024 sc1 lds
  s_add_u32 m0, s48, 24576
  s_add_u32 s67, s48, 24576
  buffer_load_dwordx4 v2, s[44:47], s67 offen sc1 lds
  buffer_load_dwordx4 v2, s[44:47], s67 offen offset:1024 sc1 lds
  s_lshl_b32 s68, s4, 3
  s_add_u32 s68, s68, s5
  s_lshl_b32 s68, s68, 2
  s_add_u32 s68, s68, s3
  s_sub_u32 s68, s68, 4
  v_lshlrev_b32 v200, 1, v2
  s_mul_i32 s67, s68, 1536
  s_mov_b32 exec_hi, 0xffff
  buffer_load_dword v196, v200, s[28:31], s67 offen
  s_mov_b32 exec_hi, -1
  s_lshl_b32 s67, s68, 11
  buffer_load_dword v197, v200, s[24:27], s67 offen
  s_branch L_role1b
L_kv:
  s_cbranch_execz L_padstart0
  s_bitcmp1_b32 s5, 0
  s_cbranch_scc1 L_isV
  s_waitcnt vmcnt(29)
  ds_read_b128 v[176:179], v80
  ds_read_b64_tr_b16 v[16:17], v208 offset:0
  ds_read_b64_tr_b16 v[18:19], v209 offset:0
  ds_read_b128 v[180:183], v81
  ds_read_b64_tr_b16 v[20:21], v208 offset:1024
  ds_read_b64_tr_b16 v[22:23], v209 offset:1024
  s_waitcnt vmcnt(21)
  ds_read_b128 v[184:187], v82
  ds_read_b64_tr_b16 v[24:25], v208 offset:2048
  ds_read_b64_tr_b16 v[26:27], v209 offset:2048
  ds_read_b128 v[188:191], v83
  ds_read_b64_tr_b16 v[28:29], v208 offset:3072
  ds_read_b64_tr_b16 v[30:31], v209 offset:3072
  s_waitcnt lgkmcnt(9)
  v_mfma_f32_16x16x32_bf16 v[212:215], v[16:19], v[176:179], 0
  s_waitcnt vmcnt(19)
  ds_read_b128 v[192:195], v84
  ds_read_b64_tr_b16 v[32:33], v208 offset:4096
  ds_read_b64_tr_b16 v[34:35], v209 offset:4096
  s_waitcnt lgkmcnt(9)
  v_mfma_f32_16x16x32_bf16 v[212:215], v[20:23], v[180:183], v[212:215]
  ds_read_b128 v[196:199], v85
  ds_read_b64_tr_b16 v[36:37], v208 offset:5120
  ds_read_b64_tr_b16 v[38:39], v209 offset:5120
  s_waitcnt lgkmcnt(9)
  v_mfma_f32_16x16x32_bf16 v[212:215], v[24:27], v[184:187], v[212:215]
  s_waitcnt vmcnt(17)
  ds_read_b128 v[200:203], v86
  ds_read_b64_tr_b16 v[40:41], v208 offset:6144
  ds_read_b64_tr_b16 v[42:43], v209 offset:6144
  s_waitcnt lgkmcnt(9)
  v_mfma_f32_16x16x32_bf16 v[212:215], v[28:31], v[188:191], v[212:215]
  ds_read_b128 v[204:207], v87
  ds_read_b64_tr_b16 v[44:45], v208 offset:7168
  ds_read_b64_tr_b16 v[46:47], v209 offset:7168
  s_waitcnt lgkmcnt(9)
  v_mfma_f32_16x16x32_bf16 v[212:215], v[32:35], v[192:195], v[212:215]
  s_waitcnt vmcnt(13)
  ds_read_b128 v[176:179], v88
  ds_read_b64_tr_b16 v[16:17], v208 offset:8192
  ds_read_b64_tr_b16 v[18:19], v209 offset:8192
  s_waitcnt lgkmcnt(9)
  v_mfma_f32_16x16x32_bf16 v[212:215], v[36:39], v[196:199], v[212:215]
  ds_read_b128 v[180:183], v89
  ds_read_b64_tr_b16 v[20:21], v208 offset:9216
  ds_read_b64_tr_b16 v[22:23], v209 offset:9216
  s_waitcnt lgkmcnt(9)
  v_mfma_f32_16x16x32_bf16 v[212:215], v[40:43], v[200:203], v[212:215]
  s_waitcnt vmcnt(8)
  ds_read_b128 v[184:187], v90
  ds_read_b64_tr_b16 v[24:25], v208 offset:10240
  ds_read_b64_tr_b16 v[26:27], v209 offset:10240
  s_waitcnt lgkmcnt(9)
  v_mfma_f32_16x16x32_bf16 v[212:215], v[44:47], v[204:207], v[212:215]
  ds_read_b128 v[188:191], v91
  ds_read_b64_tr_b16 v[28:29], v208 offset:11264
  ds_read_b64_tr_b16 v[30:31], v209 offset:11264
  s_waitcnt lgkmcnt(9)
  v_mfma_f32_16x16x32_bf16 v[212:215], v[16:19], v[176:179], v[212:215]
  s_waitcnt vmcnt(4)
  ds_read_b128 v[192:195], v92
  ds_read_b64_tr_b16 v[32:33], v208 offset:12288
  ds_read_b64_tr_b16 v[34:35], v209 offset:12288
  s_waitcnt lgkmcnt(9)
  v_mfma_f32_16x16x32_bf16 v[212:215], v[20:23], v[180:183], v[212:215]
  ds_read_b128 v[196:199], v93
  ds_read_b64_tr_b16 v[36:37], v208 offset:13312
  ds_read_b64_tr_b16 v[38:39], v209 offset:13312
  s_waitcnt lgkmcnt(9)
  v_mfma_f32_16x16x32_bf16 v[212:215], v[24:27], v[184:187], v[212:215]
  s_waitcnt vmcnt(0)
  ds_read_b128 v[200:203], v94
  ds_read_b64_tr_b16 v[40:41], v208 offset:14336
  ds_read_b64_tr_b16 v[42:43], v209 offset:14336
  s_waitcnt lgkmcnt(9)
  v_mfma_f32_16x16x32_bf16 v[212:215], v[28:31], v[188:191], v[212:215]
  ds_read_b128 v[204:207], v95
  ds_read_b64_tr_b16 v[44:45], v208 offset:15360
  ds_read_b64_tr_b16 v[46:47], v209 offset:15360
  s_waitcnt lgkmcnt(9)
  v_mfma_f32_16x16x32_bf16 v[212:215], v[32:35], v[192:195], v[212:215]
  s_waitcnt lgkmcnt(6)
  v_mfma_f32_16x16x32_bf16 v[212:215], v[36:39], v[196:199], v[212:215]
  s_waitcnt lgkmcnt(3)
  v_mfma_f32_16x16x32_bf16 v[212:215], v[40:43], v[200:203], v[212:215]
  s_waitcnt lgkmcnt(0)
  v_mfma_f32_16x16x32_bf16 v[212:215], v[44:47], v[204:207], v[212:215]
  s_nop 7
  v_cvt_pk_bf16_f32 v212, v212, v213
  v_cvt_pk_bf16_f32 v213, v214, v215
  v_min_u32 v212, -2, v212
  buffer_store_dwordx2 v[212:213], v210, s[44:47], s65 offen sc1
  s_setprio 0
  s_branch L_main0
L_isV:
  s_cbranch_execz L_padstart1
  s_waitcnt vmcnt(29)
  ds_read_b128 v[176:179], v80
  ds_read_b64_tr_b16 v[16:17], v208 offset:0
  ds_read_b64_tr_b16 v[18:19], v209 offset:0
  ds_read_b128 v[180:183], v81
  ds_read_b64_tr_b16 v[20:21], v208 offset:1024
  ds_read_b64_tr_b16 v[22:23], v209 offset:1024
  s_waitcnt vmcnt(21)
  ds_read_b128 v[184:187], v82
  ds_read_b64_tr_b16 v[24:25], v208 offset:2048
  ds_read_b64_tr_b16 v[26:27], v209 offset:2048
  ds_read_b128 v[188:191], v83
  ds_read_b64_tr_b16 v[28:29], v208 offset:3072
  ds_read_b64_tr_b16 v[30:31], v209 offset:3072
  s_waitcnt lgkmcnt(9)
  v_mfma_f32_16x16x32_bf16 v[212:215], v[176:179], v[16:19], 0
  s_waitcnt vmcnt(19)
  ds_read_b128 v[192:195], v84
  ds_read_b64_tr_b16 v[32:33], v208 offset:4096
  ds_read_b64_tr_b16 v[34:35], v209 offset:4096
  s_waitcnt lgkmcnt(9)
  v_mfma_f32_16x16x32_bf16 v[212:215], v[180:183], v[20:23], v[212:215]
  ds_read_b128 v[196:199], v85
  ds_read_b64_tr_b16 v[36:37], v208 offset:5120
  ds_read_b64_tr_b16 v[38:39], v209 offset:5120
  s_waitcnt lgkmcnt(9)
  v_mfma_f32_16x16x32_bf16 v[212:215], v[184:187], v[24:27], v[212:215]
  s_waitcnt vmcnt(17)
  ds_read_b128 v[200:203], v86
  ds_read_b64_tr_b16 v[40:41], v208 offset:6144
  ds_read_b64_tr_b16 v[42:43], v209 offset:6144
  s_waitcnt lgkmcnt(9)
  v_mfma_f32_16x16x32_bf16 v[212:215], v[188:191], v[28:31], v[212:215]
  ds_read_b128 v[204:207], v87
  ds_read_b64_tr_b16 v[44:45], v208 offset:7168
  ds_read_b64_tr_b16 v[46:47], v209 offset:7168
  s_waitcnt lgkmcnt(9)
  v_mfma_f32_16x16x32_bf16 v[212:215], v[192:195], v[32:35], v[212:215]
  s_waitcnt vmcnt(13)
  ds_read_b128 v[176:179], v88
  ds_read_b64_tr_b16 v[16:17], v208 offset:8192
  ds_read_b64_tr_b16 v[18:19], v209 offset:8192
  s_waitcnt lgkmcnt(9)
  v_mfma_f32_16x16x32_bf16 v[212:215], v[196:199], v[36:39], v[212:215]
  ds_read_b128 v[180:183], v89
  ds_read_b64_tr_b16 v[20:21], v208 offset:9216
  ds_read_b64_tr_b16 v[22:23], v209 offset:9216
  s_waitcnt lgkmcnt(9)
  v_mfma_f32_16x16x32_bf16 v[212:215], v[200:203], v[40:43], v[212:215]
  s_waitcnt vmcnt(8)
  ds_read_b128 v[184:187], v90
  ds_read_b64_tr_b16 v[24:25], v208 offset:10240
  ds_read_b64_tr_b16 v[26:27], v209 offset:10240
  s_waitcnt lgkmcnt(9)
  v_mfma_f32_16x16x32_bf16 v[212:215], v[204:207], v[44:47], v[212:215]
  ds_read_b128 v[188:191], v91
  ds_read_b64_tr_b16 v[28:29], v208 offset:11264
  ds_read_b64_tr_b16 v[30:31], v209 offset:11264
  s_waitcnt lgkmcnt(9)
  v_mfma_f32_16x16x32_bf16 v[212:215], v[176:179], v[16:19], v[212:215]
  s_waitcnt vmcnt(4)
  ds_read_b128 v[192:195], v92
  ds_read_b64_tr_b16 v[32:33], v208 offset:12288
  ds_read_b64_tr_b16 v[34:35], v209 offset:12288
  s_waitcnt lgkmcnt(9)
  v_mfma_f32_16x16x32_bf16 v[212:215], v[180:183], v[20:23], v[212:215]
  ds_read_b128 v[196:199], v93
  ds_read_b64_tr_b16 v[36:37], v208 offset:13312
  ds_read_b64_tr_b16 v[38:39], v209 offset:13312
  s_waitcnt lgkmcnt(9)
  v_mfma_f32_16x16x32_bf16 v[212:215], v[184:187], v[24:27], v[212:215]
  s_waitcnt vmcnt(0)
  ds_read_b128 v[200:203], v94
  ds_read_b64_tr_b16 v[40:41], v208 offset:14336
  ds_read_b64_tr_b16 v[42:43], v209 offset:14336
  s_waitcnt lgkmcnt(9)
  v_mfma_f32_16x16x32_bf16 v[212:215], v[188:191], v[28:31], v[212:215]
  ds_read_b128 v[204:207], v95
  ds_read_b64_tr_b16 v[44:45], v208 offset:15360
  ds_read_b64_tr_b16 v[46:47], v209 offset:15360
  s_waitcnt lgkmcnt(9)
  v_mfma_f32_16x16x32_bf16 v[212:215], v[192:195], v[32:35], v[212:215]
  s_waitcnt lgkmcnt(6)
  v_mfma_f32_16x16x32_bf16 v[212:215], v[196:199], v[36:39], v[212:215]
  s_waitcnt lgkmcnt(3)
  v_mfma_f32_16x16x32_bf16 v[212:215], v[200:203], v[40:43], v[212:215]
  s_waitcnt lgkmcnt(0)
  v_mfma_f32_16x16x32_bf16 v[212:215], v[204:207], v[44:47], v[212:215]
  s_nop 7
  v_cvt_pk_bf16_f32 v212, v212, v213
  v_cvt_pk_bf16_f32 v213, v214, v215
  v_min_u32 v212, -2, v212
  buffer_store_dwordx2 v[212:213], v210, s[44:47], s65 offen sc1
  s_setprio 0
  s_branch L_main0
.p2align 12
L_page0:
L_main0:
  v_and_b32 v251, 27, v1
  v_cmp_eq_u32 vcc, 16, v251
  v_mov_b32 v252, 0x3f803f80
  v_mov_b32 v253, 0
  v_cndmask_b32 v96, v253, v252, vcc
  v_mov_b32 v97, v96
  v_mov_b32 v98, v96
  v_mov_b32 v99, v96
  v_mov_b32 v104, v96
  v_mov_b32 v105, v96
  v_mov_b32 v106, v96
  v_mov_b32 v107, v96
  v_mov_b32 v100, v96
  v_mov_b32 v101, v96
  v_mov_b32 v102, v96
  v_mov_b32 v103, v96
  v_mov_b32 v108, v96
  v_mov_b32 v109, v96
  v_mov_b32 v110, v96
  v_mov_b32 v111, v96
  v_mov_b32 v144, v96
  v_mov_b32 v145, v96
  v_mov_b32 v146, v96
  v_mov_b32 v147, v96
  v_mov_b32 v148, v96
  v_mov_b32 v149, v96
  v_mov_b32 v150, v96
  v_mov_b32 v151, v96
  v_mov_b32 v152, v96
  v_mov_b32 v153, v96
  v_mov_b32 v154, v96
  v_mov_b32 v155, v96
  v_mov_b32 v156, v96
  v_mov_b32 v157, v96
  v_mov_b32 v158, v96
  v_mov_b32 v159, v96
  v_mov_b32 v48, 0
  v_mov_b32 v49, 0
  v_mov_b32 v50, 0
  v_mov_b32 v51, 0
  v_mov_b32 v52, 0
  v_mov_b32 v53, 0
  v_mov_b32 v54, 0
  v_mov_b32 v55, 0
  v_mov_b32 v56, 0
  v_mov_b32 v57, 0
  v_mov_b32 v58, 0
  v_mov_b32 v59, 0
  v_mov_b32 v60, 0
  v_mov_b32 v61, 0
  v_mov_b32 v62, 0
  v_mov_b32 v63, 0
  v_mov_b32 v64, 0
  v_mov_b32 v65, 0
  v_mov_b32 v66, 0
  v_mov_b32 v67, 0
  v_mov_b32 v68, 0
  v_mov_b32 v69, 0
  v_mov_b32 v70, 0
  v_mov_b32 v71, 0
  v_mov_b32 v72, 0
  v_mov_b32 v73, 0
  v_mov_b32 v74, 0
  v_mov_b32 v75, 0
  v_mov_b32 v76, 0
  v_mov_b32 v77, 0
  v_mov_b32 v78, 0
  v_mov_b32 v79, 0
  s_barrier
  ds_read_b128 v[160:163], v224 offset:32768
  ds_read_b64_tr_b16 v[164:165], v8 offset:32768
  ds_read_b64_tr_b16 v[166:167], v8 offset:33280
  ds_read_b128 v[168:171], v225 offset:32768
  ds_read_b64_tr_b16 v[172:173], v8 offset:34816
  ds_read_b64_tr_b16 v[174:175], v8 offset:35328
  ds_read_b128 v[176:179], v226 offset:32768
  ds_read_b64_tr_b16 v[180:181], v8 offset:36864
  ds_read_b64_tr_b16 v[182:183], v8 offset:37376
  ds_read_b128 v[184:187], v227 offset:32768
  ds_read_b64_tr_b16 v[188:189], v8 offset:38912
  ds_read_b64_tr_b16 v[190:191], v8 offset:39424
  s_waitcnt lgkmcnt(9)
  v_mfma_f32_32x32x16_bf16 v[112:127], v[164:167], v[160:163], 0
  ds_read_b128 v[192:195], v224 offset:40960
  ds_read_b64_tr_b16 v[196:197], v8 offset:40960
  ds_read_b64_tr_b16 v[198:199], v8 offset:41472
  s_waitcnt lgkmcnt(9)
  v_mfma_f32_32x32x16_bf16 v[112:127], v[172:175], v[168:171], v[112:127]
  ds_read_b128 v[200:203], v225 offset:40960
  ds_read_b64_tr_b16 v[204:205], v8 offset:43008
  ds_read_b64_tr_b16 v[206:207], v8 offset:43520
  s_waitcnt lgkmcnt(9)
  v_mfma_f32_32x32x16_bf16 v[112:127], v[180:183], v[176:179], v[112:127]
  ds_read_b128 v[160:163], v226 offset:40960
  ds_read_b64_tr_b16 v[164:165], v8 offset:45056
  ds_read_b64_tr_b16 v[166:167], v8 offset:45568
  s_waitcnt lgkmcnt(9)
  v_mfma_f32_32x32x16_bf16 v[112:127], v[188:191], v[184:187], v[112:127]
  ds_read_b128 v[168:171], v227 offset:40960
  ds_read_b64_tr_b16 v[172:173], v8 offset:47104
  ds_read_b64_tr_b16 v[174:175], v8 offset:47616
  s_waitcnt lgkmcnt(9)
  v_mfma_f32_32x32x16_bf16 v[112:127], v[196:199], v[192:195], v[112:127]
  s_waitcnt lgkmcnt(6)
  v_mfma_f32_32x32x16_bf16 v[112:127], v[204:207], v[200:203], v[112:127]
  s_waitcnt lgkmcnt(3)
  v_mfma_f32_32x32x16_bf16 v[112:127], v[164:167], v[160:163], v[112:127]
  s_waitcnt lgkmcnt(0)
  v_mfma_f32_32x32x16_bf16 v[112:127], v[172:175], v[168:171], v[112:127]
  s_barrier
  ds_read_b128 v[176:179], v224 offset:49152
  ds_read_b64_tr_b16 v[180:181], v8 offset:49152
  ds_read_b64_tr_b16 v[182:183], v8 offset:49664
  ds_read_b128 v[184:187], v225 offset:49152
  ds_read_b64_tr_b16 v[188:189], v8 offset:51200
  ds_read_b64_tr_b16 v[190:191], v8 offset:51712
  ds_read_b128 v[192:195], v226 offset:49152
  ds_read_b64_tr_b16 v[196:197], v8 offset:53248
  ds_read_b64_tr_b16 v[198:199], v8 offset:53760
  ds_read_b128 v[200:203], v227 offset:49152
  ds_read_b64_tr_b16 v[204:205], v8 offset:55296
  ds_read_b64_tr_b16 v[206:207], v8 offset:55808
  s_waitcnt lgkmcnt(9)
  v_mfma_f32_32x32x16_bf16 v[112:127], v[180:183], v[176:179], v[112:127]
  ds_read_b128 v[160:163], v224 offset:57344
  ds_read_b64_tr_b16 v[164:165], v8 offset:57344
  ds_read_b64_tr_b16 v[166:167], v8 offset:57856
  s_waitcnt lgkmcnt(9)
  v_mfma_f32_32x32x16_bf16 v[112:127], v[188:191], v[184:187], v[112:127]
  ds_read_b128 v[168:171], v225 offset:57344
  ds_read_b64_tr_b16 v[172:173], v8 offset:59392
  ds_read_b64_tr_b16 v[174:175], v8 offset:59904
  s_waitcnt lgkmcnt(9)
  v_mfma_f32_32x32x16_bf16 v[112:127], v[196:199], v[192:195], v[112:127]
  ds_read_b128 v[176:179], v226 offset:57344
  ds_read_b64_tr_b16 v[180:181], v8 offset:61440
  ds_read_b64_tr_b16 v[182:183], v8 offset:61952
  s_waitcnt lgkmcnt(9)
  v_mfma_f32_32x32x16_bf16 v[112:127], v[204:207], v[200:203], v[112:127]
  ds_read_b128 v[184:187], v227 offset:57344
  ds_read_b64_tr_b16 v[188:189], v8 offset:63488
  ds_read_b64_tr_b16 v[190:191], v8 offset:64000
  s_waitcnt lgkmcnt(9)
  v_mfma_f32_32x32x16_bf16 v[112:127], v[164:167], v[160:163], v[112:127]
  s_waitcnt lgkmcnt(6)
  v_mfma_f32_32x32x16_bf16 v[112:127], v[172:175], v[168:171], v[112:127]
  s_waitcnt lgkmcnt(3)
  v_mfma_f32_32x32x16_bf16 v[112:127], v[180:183], v[176:179], v[112:127]
  s_waitcnt lgkmcnt(0)
  v_mfma_f32_32x32x16_bf16 v[112:127], v[188:191], v[184:187], v[112:127]
  s_barrier
  ds_read_b128 v[192:195], v224 offset:0
  ds_read_b64_tr_b16 v[196:197], v8 offset:0
  ds_read_b64_tr_b16 v[198:199], v8 offset:512
  ds_read_b128 v[200:203], v225 offset:0
  ds_read_b64_tr_b16 v[204:205], v8 offset:2048
  ds_read_b64_tr_b16 v[206:207], v8 offset:2560
  ds_read_b128 v[160:163], v226 offset:0
  ds_read_b64_tr_b16 v[164:165], v8 offset:4096
  ds_read_b64_tr_b16 v[166:167], v8 offset:4608
  ds_read_b128 v[168:171], v227 offset:0
  ds_read_b64_tr_b16 v[172:173], v8 offset:6144
  ds_read_b64_tr_b16 v[174:175], v8 offset:6656
  s_waitcnt lgkmcnt(9)
  v_mfma_f32_32x32x16_bf16 v[112:127], v[196:199], v[192:195], v[112:127]
  ds_read_b128 v[176:179], v224 offset:8192
  ds_read_b64_tr_b16 v[180:181], v8 offset:8192
  ds_read_b64_tr_b16 v[182:183], v8 offset:8704
  s_waitcnt lgkmcnt(9)
  v_mfma_f32_32x32x16_bf16 v[112:127], v[204:207], v[200:203], v[112:127]
  ds_read_b128 v[184:187], v225 offset:8192
  ds_read_b64_tr_b16 v[188:189], v8 offset:10240
  ds_read_b64_tr_b16 v[190:191], v8 offset:10752
  s_waitcnt lgkmcnt(9)
  v_mfma_f32_32x32x16_bf16 v[112:127], v[164:167], v[160:163], v[112:127]
  ds_read_b128 v[192:195], v226 offset:8192
  ds_read_b64_tr_b16 v[196:197], v8 offset:12288
  ds_read_b64_tr_b16 v[198:199], v8 offset:12800
  s_waitcnt lgkmcnt(9)
  v_mfma_f32_32x32x16_bf16 v[112:127], v[172:175], v[168:171], v[112:127]
  ds_read_b128 v[200:203], v227 offset:8192
  ds_read_b64_tr_b16 v[204:205], v8 offset:14336
  ds_read_b64_tr_b16 v[206:207], v8 offset:14848
  s_waitcnt lgkmcnt(9)
  v_mfma_f32_32x32x16_bf16 v[112:127], v[180:183], v[176:179], v[112:127]
  s_waitcnt lgkmcnt(6)
  v_mfma_f32_32x32x16_bf16 v[112:127], v[188:191], v[184:187], v[112:127]
  s_waitcnt lgkmcnt(3)
  v_mfma_f32_32x32x16_bf16 v[112:127], v[196:199], v[192:195], v[112:127]
  s_waitcnt lgkmcnt(0)
  v_mfma_f32_32x32x16_bf16 v[112:127], v[204:207], v[200:203], v[112:127]
  s_waitcnt vmcnt(0)
  v_or_b32 v247, s71, v4
  s_barrier
  ds_read_b128 v[160:163], v224 offset:16384
  ds_read_b64_tr_b16 v[164:165], v8 offset:16384
  ds_read_b64_tr_b16 v[166:167], v8 offset:16896
  ds_read_b128 v[168:171], v225 offset:16384
  ds_read_b64_tr_b16 v[172:173], v8 offset:18432
  ds_read_b64_tr_b16 v[174:175], v8 offset:18944
  ds_read_b128 v[176:179], v226 offset:16384
  ds_read_b64_tr_b16 v[180:181], v8 offset:20480
  ds_read_b64_tr_b16 v[182:183], v8 offset:20992
  ds_read_b128 v[184:187], v227 offset:16384
  ds_read_b64_tr_b16 v[188:189], v8 offset:22528
  ds_read_b64_tr_b16 v[190:191], v8 offset:23040
  s_waitcnt lgkmcnt(9)
  v_mfma_f32_32x32x16_bf16 v[112:127], v[164:167], v[160:163], v[112:127]
  ds_read_b128 v[192:195], v224 offset:24576
  ds_read_b64_tr_b16 v[196:197], v8 offset:24576
  ds_read_b64_tr_b16 v[198:199], v8 offset:25088
  s_waitcnt lgkmcnt(9)
  v_mfma_f32_32x32x16_bf16 v[112:127], v[172:175], v[168:171], v[112:127]
  ds_read_b128 v[200:203], v225 offset:24576
  ds_read_b64_tr_b16 v[204:205], v8 offset:26624
  ds_read_b64_tr_b16 v[206:207], v8 offset:27136
  s_waitcnt lgkmcnt(9)
  v_mfma_f32_32x32x16_bf16 v[112:127], v[180:183], v[176:179], v[112:127]
  ds_read_b128 v[160:163], v226 offset:24576
  ds_read_b64_tr_b16 v[164:165], v8 offset:28672
  ds_read_b64_tr_b16 v[166:167], v8 offset:29184
  s_waitcnt lgkmcnt(9)
  v_mfma_f32_32x32x16_bf16 v[112:127], v[188:191], v[184:187], v[112:127]
  ds_read_b128 v[168:171], v227 offset:24576
  ds_read_b64_tr_b16 v[172:173], v8 offset:30720
  ds_read_b64_tr_b16 v[174:175], v8 offset:31232
  s_waitcnt lgkmcnt(9)
  v_mfma_f32_32x32x16_bf16 v[112:127], v[196:199], v[192:195], v[112:127]
  s_waitcnt lgkmcnt(6)
  v_mfma_f32_32x32x16_bf16 v[112:127], v[204:207], v[200:203], v[112:127]
  s_waitcnt lgkmcnt(3)
  v_mfma_f32_32x32x16_bf16 v[112:127], v[164:167], v[160:163], v[112:127]
  s_waitcnt lgkmcnt(0)
  v_mfma_f32_32x32x16_bf16 v[112:127], v[172:175], v[168:171], v[112:127]
  s_nop 7
  s_nop 3
  v_mul_f32 v112, 0x3eb8aa3b, v112
  v_mul_f32 v113, 0x3eb8aa3b, v113
  v_mul_f32 v114, 0x3eb8aa3b, v114
  v_mul_f32 v115, 0x3eb8aa3b, v115
  v_mul_f32 v116, 0x3eb8aa3b, v116
  v_mul_f32 v117, 0x3eb8aa3b, v117
  v_mul_f32 v118, 0x3eb8aa3b, v118
  v_mul_f32 v119, 0x3eb8aa3b, v119
  v_cvt_pk_bf16_f32 v80, v112, v113
  v_cvt_pk_bf16_f32 v81, v114, v115
  v_cvt_pk_bf16_f32 v82, v116, v117
  v_cvt_pk_bf16_f32 v83, v118, v119
  v_mul_f32 v120, 0x3eb8aa3b, v120
  v_mul_f32 v121, 0x3eb8aa3b, v121
  v_mul_f32 v122, 0x3eb8aa3b, v122
  v_mul_f32 v123, 0x3eb8aa3b, v123
  v_mul_f32 v124, 0x3eb8aa3b, v124
  v_mul_f32 v125, 0x3eb8aa3b, v125
  v_mul_f32 v126, 0x3eb8aa3b, v126
  v_mul_f32 v127, 0x3eb8aa3b, v127
  v_cvt_pk_bf16_f32 v84, v120, v121
  v_cvt_pk_bf16_f32 v85, v122, v123
  v_cvt_pk_bf16_f32 v86, v124, v125
  v_cvt_pk_bf16_f32 v87, v126, v127
  s_waitcnt vmcnt(0)
  buffer_store_dword v247, v3, s[44:47], s70 offen sc1
  v_add_u32 v224, s56, v224
  v_add_u32 v225, s56, v225
  s_barrier
  ds_read_b128 v[88:91], v6
  ds_read_b128 v[92:95], v6 offset:4096
  s_mov_b64 exec, s[52:53]
  ds_read_b128 v[96:99], v7
  ds_read_b128 v[100:103], v7 offset:512
  s_mov_b64 exec, -1
  ds_write_b128 v240, v[80:83] offset:16384
  ds_write_b128 v240, v[84:87] offset:17408
  s_waitcnt lgkmcnt(5)
  v_mfma_f32_32x32x16_bf16 v[16:31], v[88:91], v[80:83], 0
  v_mfma_f32_32x32x16_bf16 v[32:47], v[88:91], v[84:87], 0
  s_nop 7
  s_nop 2
  v_exp_f32 v16, v16
  s_setprio 1
  v_exp_f32 v17, v17
  v_exp_f32 v18, v18
  s_waitcnt lgkmcnt(0)
  s_barrier
  v_exp_f32 v19, v19
  v_exp_f32 v20, v20
  v_exp_f32 v21, v21
  v_exp_f32 v22, v22
  v_exp_f32 v23, v23
  v_exp_f32 v24, v24
  v_exp_f32 v25, v25
  v_exp_f32 v26, v26
  v_exp_f32 v27, v27
  v_exp_f32 v28, v28
  v_exp_f32 v29, v29
  v_exp_f32 v30, v30
  v_exp_f32 v31, v31
  v_exp_f32 v32, v32
  v_exp_f32 v33, v33
  v_exp_f32 v34, v34
  v_exp_f32 v35, v35
  v_exp_f32 v36, v36
  v_exp_f32 v37, v37
  v_exp_f32 v38, v38
  v_exp_f32 v39, v39
  v_exp_f32 v40, v40
  v_exp_f32 v41, v41
  v_exp_f32 v42, v42
  v_exp_f32 v43, v43
  v_exp_f32 v44, v44
  v_exp_f32 v45, v45
  v_exp_f32 v46, v46
  v_exp_f32 v47, v47
  s_setprio 3
  v_smfmac_f32_32x32x32_bf16 v[48:63], v[96:99], v[16:23], v5
  s_barrier
  v_smfmac_f32_32x32x32_bf16 v[48:63], v[100:103], v[24:31], v5
  s_add_u32 s8, s77, 4096
  s_add_u32 s9, s77, 8192
  s_add_u32 s10, s77, 12288
  v_smfmac_f32_32x32x32_bf16 v[64:79], v[100:103], v[40:47], v5
  s_mov_b32 s12, 0x3fb8aa3b
  s_mov_b32 s13, s12
  s_mov_b32 s16, 0x358637bd
  s_mov_b32 s17, s16
  v_smfmac_f32_32x32x32_bf16 v[64:79], v[96:99], v[32:39], v5
  s_mov_b64 exec, s[52:53]
  ds_read_b128 v[104:107], v7 offset:4096
  ds_read_b128 v[108:111], v7 offset:4608
  s_mov_b64 exec, -1
  v_mfma_f32_32x32x16_bf16 v[16:31], v[92:95], v[80:83], 0
  ds_read_b128 v[88:91], v6 offset:8192
  v_mfma_f32_32x32x16_bf16 v[32:47], v[92:95], v[84:87], 0
  s_nop 9
  s_setprio 0
  v_exp_f32 v16, v16
  s_setprio 1
  v_exp_f32 v17, v17
  v_exp_f32 v18, v18
  v_exp_f32 v19, v19
  v_exp_f32 v20, v20
  v_exp_f32 v21, v21
  v_exp_f32 v22, v22
  v_exp_f32 v23, v23
  v_exp_f32 v24, v24
  v_exp_f32 v25, v25
  v_exp_f32 v26, v26
  v_exp_f32 v27, v27
  v_exp_f32 v28, v28
  v_exp_f32 v29, v29
  v_exp_f32 v30, v30
  v_exp_f32 v31, v31
  v_exp_f32 v32, v32
  v_exp_f32 v33, v33
  v_exp_f32 v34, v34
  v_exp_f32 v35, v35
  v_exp_f32 v36, v36
  v_exp_f32 v37, v37
  v_exp_f32 v38, v38
  v_exp_f32 v39, v39
  v_exp_f32 v40, v40
  v_exp_f32 v41, v41
  v_exp_f32 v42, v42
  v_exp_f32 v43, v43
  v_exp_f32 v44, v44
  v_exp_f32 v45, v45
  v_exp_f32 v46, v46
  v_exp_f32 v47, v47
  s_setprio 3
  s_waitcnt lgkmcnt(0)
  v_smfmac_f32_32x32x32_bf16 v[48:63], v[104:107], v[16:23], v5
  v_smfmac_f32_32x32x32_bf16 v[48:63], v[108:111], v[24:31], v5
  s_add_u32 m0, s57, 32768
  s_mov_b32 s58, 0
  buffer_load_dwordx4 v10, s[24:27], s58 offen lds
  v_smfmac_f32_32x32x32_bf16 v[64:79], v[108:111], v[40:47], v5
  s_add_u32 m0, s57, 40960
  s_mov_b32 s58, 65536
  buffer_load_dwordx4 v10, s[24:27], s58 offen lds
  v_smfmac_f32_32x32x32_bf16 v[64:79], v[104:107], v[32:39], v5
  s_mov_b64 exec, s[52:53]
  ds_read_b128 v[96:99], v7 offset:8192
  ds_read_b128 v[100:103], v7 offset:8704
  s_mov_b64 exec, -1
  v_mfma_f32_32x32x16_bf16 v[16:31], v[88:91], v[80:83], 0
  ds_read_b128 v[92:95], v6 offset:12288
  s_add_u32 m0, s57, 98304
  s_mov_b32 s58, 0
  buffer_load_dwordx4 v12, s[28:31], s58 offen lds
  v_mfma_f32_32x32x16_bf16 v[32:47], v[88:91], v[84:87], 0
  s_add_u32 m0, s57, 106496
  s_mov_b32 s58, 0
  buffer_load_dwordx4 v11, s[28:31], s58 offen lds
  s_nop 9
  s_setprio 0
  v_exp_f32 v16, v16
  s_setprio 1
  v_exp_f32 v17, v17
  v_exp_f32 v18, v18
  v_exp_f32 v19, v19
  v_exp_f32 v20, v20
  v_exp_f32 v21, v21
  v_exp_f32 v22, v22
  v_exp_f32 v23, v23
  v_exp_f32 v24, v24
  v_exp_f32 v25, v25
  v_exp_f32 v26, v26
  v_exp_f32 v27, v27
  v_exp_f32 v28, v28
  v_exp_f32 v29, v29
  v_exp_f32 v30, v30
  v_exp_f32 v31, v31
  v_exp_f32 v32, v32
  v_exp_f32 v33, v33
  v_exp_f32 v34, v34
  v_exp_f32 v35, v35
  v_exp_f32 v36, v36
  v_exp_f32 v37, v37
  v_exp_f32 v38, v38
  v_exp_f32 v39, v39
  v_exp_f32 v40, v40
  v_exp_f32 v41, v41
  v_exp_f32 v42, v42
  v_exp_f32 v43, v43
  v_exp_f32 v44, v44
  v_exp_f32 v45, v45
  v_exp_f32 v46, v46
  v_exp_f32 v47, v47
  s_setprio 3
  s_waitcnt lgkmcnt(0)
  v_smfmac_f32_32x32x32_bf16 v[48:63], v[96:99], v[16:23], v5
  s_barrier
  buffer_load_dword v247, v244, s[44:47], s54 offen sc1
  v_smfmac_f32_32x32x32_bf16 v[48:63], v[100:103], v[24:31], v5
  v_smfmac_f32_32x32x32_bf16 v[64:79], v[100:103], v[40:47], v5
  v_smfmac_f32_32x32x32_bf16 v[64:79], v[96:99], v[32:39], v5
  s_mov_b64 exec, s[52:53]
  ds_read_b128 v[104:107], v7 offset:12288
  ds_read_b128 v[108:111], v7 offset:12800
  s_mov_b64 exec, -1
  v_mfma_f32_32x32x16_bf16 v[16:31], v[92:95], v[80:83], 0
  ds_read_b128 v[88:91], v6 offset:16384
  s_add_u32 m0, s57, 49152
  s_mov_b32 s58, 128
  buffer_load_dwordx4 v10, s[24:27], s58 offen lds
  v_mfma_f32_32x32x16_bf16 v[32:47], v[92:95], v[84:87], 0
  s_add_u32 m0, s57, 57344
  s_mov_b32 s58, 65664
  buffer_load_dwordx4 v10, s[24:27], s58 offen lds
  s_nop 9
  s_setprio 0
  v_exp_f32 v16, v16
  s_setprio 1
  v_exp_f32 v17, v17
  v_exp_f32 v18, v18
  v_exp_f32 v19, v19
  v_exp_f32 v20, v20
  v_exp_f32 v21, v21
  v_exp_f32 v22, v22
  v_exp_f32 v23, v23
  v_exp_f32 v24, v24
  v_exp_f32 v25, v25
  v_exp_f32 v26, v26
  v_exp_f32 v27, v27
  v_exp_f32 v28, v28
  v_exp_f32 v29, v29
  v_exp_f32 v30, v30
  v_exp_f32 v31, v31
  v_exp_f32 v32, v32
  v_exp_f32 v33, v33
  v_exp_f32 v34, v34
  v_exp_f32 v35, v35
  v_exp_f32 v36, v36
  v_exp_f32 v37, v37
  v_exp_f32 v38, v38
  v_exp_f32 v39, v39
  v_exp_f32 v40, v40
  v_exp_f32 v41, v41
  v_exp_f32 v42, v42
  v_exp_f32 v43, v43
  v_exp_f32 v44, v44
  v_exp_f32 v45, v45
  v_exp_f32 v46, v46
  v_exp_f32 v47, v47
  s_setprio 3
  s_waitcnt lgkmcnt(0)
  v_smfmac_f32_32x32x32_bf16 v[48:63], v[104:107], v[16:23], v5
  v_smfmac_f32_32x32x32_bf16 v[48:63], v[108:111], v[24:31], v5
  v_smfmac_f32_32x32x32_bf16 v[64:79], v[108:111], v[40:47], v5
  v_smfmac_f32_32x32x32_bf16 v[64:79], v[104:107], v[32:39], v5
  s_mov_b64 exec, s[52:53]
  ds_read_b128 v[96:99], v7 offset:16384
  ds_read_b128 v[100:103], v7 offset:16896
  s_mov_b64 exec, -1
  v_mfma_f32_32x32x16_bf16 v[16:31], v[88:91], v[80:83], 0
  ds_read_b128 v[92:95], v6 offset:20480
  s_add_u32 m0, s57, 114688
  s_mov_b32 s58, 196608
  buffer_load_dwordx4 v12, s[28:31], s58 offen lds
  v_mfma_f32_32x32x16_bf16 v[32:47], v[88:91], v[84:87], 0
  s_add_u32 m0, s57, 122880
  s_mov_b32 s58, 196608
  buffer_load_dwordx4 v11, s[28:31], s58 offen lds
  s_nop 9
  s_setprio 0
  v_exp_f32 v16, v16
  s_setprio 1
  v_exp_f32 v17, v17
  v_exp_f32 v18, v18
  v_exp_f32 v19, v19
  v_exp_f32 v20, v20
  v_exp_f32 v21, v21
  v_exp_f32 v22, v22
  v_exp_f32 v23, v23
  v_exp_f32 v24, v24
  v_exp_f32 v25, v25
  v_exp_f32 v26, v26
  v_exp_f32 v27, v27
  s_waitcnt vmcnt(4)
  v_xor_b32 v247, v247, v4
  v_cmp_lt_u32 vcc, 15, v247
  v_exp_f32 v28, v28
  v_exp_f32 v29, v29
  v_exp_f32 v30, v30
  v_exp_f32 v31, v31
  v_exp_f32 v32, v32
  v_exp_f32 v33, v33
  v_exp_f32 v34, v34
  v_exp_f32 v35, v35
  v_exp_f32 v36, v36
  v_exp_f32 v37, v37
  v_exp_f32 v38, v38
  v_exp_f32 v39, v39
  v_exp_f32 v40, v40
  v_exp_f32 v41, v41
  v_exp_f32 v42, v42
  v_exp_f32 v43, v43
  v_exp_f32 v44, v44
  v_exp_f32 v45, v45
  v_exp_f32 v46, v46
  v_exp_f32 v47, v47
  s_setprio 3
  s_waitcnt lgkmcnt(0)
  v_smfmac_f32_32x32x32_bf16 v[48:63], v[96:99], v[16:23], v5
  s_cbranch_vccnz L_spin_p1b
L_back_p1b:
  s_barrier
  ds_read_b128 v[128:131], v228 offset:0
  ds_read_b64_tr_b16 v[132:133], v9 offset:0
  ds_read_b64_tr_b16 v[134:135], v9 offset:512
  v_smfmac_f32_32x32x32_bf16 v[48:63], v[100:103], v[24:31], v5
  ds_read_b128 v[176:179], v229 offset:0
  ds_read_b64_tr_b16 v[180:181], v9 offset:2048
  ds_read_b64_tr_b16 v[182:183], v9 offset:2560
  v_smfmac_f32_32x32x32_bf16 v[64:79], v[100:103], v[40:47], v5
  ds_read_b128 v[184:187], v224 offset:0
  ds_read_b64_tr_b16 v[188:189], v8 offset:8192
  ds_read_b64_tr_b16 v[190:191], v8 offset:8704
  v_smfmac_f32_32x32x32_bf16 v[64:79], v[96:99], v[32:39], v5
  s_mov_b64 exec, s[52:53]
  ds_read_b128 v[104:107], v7 offset:20480
  ds_read_b128 v[108:111], v7 offset:20992
  s_mov_b64 exec, -1
  s_add_u32 m0, s57, 0
  s_mov_b32 s58, 32768
  buffer_load_dwordx4 v14, s[44:47], s58 offen sc1 lds
  v_mfma_f32_32x32x16_bf16 v[16:31], v[92:95], v[80:83], 0
  ds_read_b128 v[88:91], v6 offset:24576
  s_add_u32 m0, s57, 65536
  s_mov_b32 s58, 256
  buffer_load_dwordx4 v10, s[24:27], s58 offen lds
  v_mfma_f32_32x32x16_bf16 v[32:47], v[92:95], v[84:87], 0
  s_add_u32 m0, s57, 73728
  s_mov_b32 s58, 65792
  buffer_load_dwordx4 v10, s[24:27], s58 offen lds
  s_waitcnt lgkmcnt(3)
  v_mfma_f32_32x32x16_bf16 v[112:127], v[128:131], v[132:135], 0
  v_mfma_f32_32x32x16_bf16 v[112:127], v[176:179], v[180:183], v[112:127]
  v_mfma_f32_32x32x16_bf16 v[208:223], v[188:191], v[184:187], 0
  s_setprio 0
  v_exp_f32 v16, v16
  s_setprio 1
  v_exp_f32 v17, v17
  v_exp_f32 v18, v18
  v_exp_f32 v19, v19
  v_exp_f32 v20, v20
  v_exp_f32 v21, v21
  v_exp_f32 v22, v22
  v_exp_f32 v23, v23
  v_exp_f32 v24, v24
  v_exp_f32 v25, v25
  v_exp_f32 v26, v26
  v_exp_f32 v27, v27
  v_exp_f32 v28, v28
  v_exp_f32 v29, v29
  v_exp_f32 v30, v30
  v_exp_f32 v31, v31
  v_exp_f32 v32, v32
  v_exp_f32 v33, v33
  v_exp_f32 v34, v34
  v_exp_f32 v35, v35
  v_exp_f32 v36, v36
  v_exp_f32 v37, v37
  v_exp_f32 v38, v38
  v_exp_f32 v39, v39
  v_exp_f32 v40, v40
  v_exp_f32 v41, v41
  v_exp_f32 v42, v42
  v_exp_f32 v43, v43
  v_exp_f32 v44, v44
  v_exp_f32 v45, v45
  v_exp_f32 v46, v46
  v_exp_f32 v47, v47
  s_setprio 3
  s_waitcnt lgkmcnt(0)
  v_smfmac_f32_32x32x32_bf16 v[48:63], v[104:107], v[16:23], v5
  ds_read_b128 v[128:131], v230 offset:0
  ds_read_b64_tr_b16 v[132:133], v9 offset:4096
  ds_read_b64_tr_b16 v[134:135], v9 offset:4608
  v_smfmac_f32_32x32x32_bf16 v[48:63], v[108:111], v[24:31], v5
  ds_read_b128 v[176:179], v231 offset:0
  ds_read_b64_tr_b16 v[180:181], v9 offset:6144
  ds_read_b64_tr_b16 v[182:183], v9 offset:6656
  v_smfmac_f32_32x32x32_bf16 v[64:79], v[108:111], v[40:47], v5
  ds_read_b128 v[184:187], v225 offset:0
  ds_read_b64_tr_b16 v[188:189], v8 offset:10240
  ds_read_b64_tr_b16 v[190:191], v8 offset:10752
  v_smfmac_f32_32x32x32_bf16 v[64:79], v[104:107], v[32:39], v5
  s_mov_b64 exec, s[52:53]
  ds_read_b128 v[96:99], v7 offset:24576
  ds_read_b128 v[100:103], v7 offset:25088
  s_mov_b64 exec, -1
  s_add_u32 m0, s57, 8192
  s_mov_b32 s58, 40960
  buffer_load_dwordx4 v14, s[44:47], s58 offen sc1 lds
  v_mfma_f32_32x32x16_bf16 v[16:31], v[88:91], v[80:83], 0
  ds_read_b128 v[92:95], v6 offset:28672
  s_add_u32 m0, s57, 131072
  s_mov_b32 s58, 393216
  buffer_load_dwordx4 v12, s[28:31], s58 offen lds
  v_mfma_f32_32x32x16_bf16 v[32:47], v[88:91], v[84:87], 0
  s_add_u32 m0, s57, 139264
  s_mov_b32 s58, 393216
  buffer_load_dwordx4 v11, s[28:31], s58 offen lds
  s_waitcnt lgkmcnt(3)
  v_mfma_f32_32x32x16_bf16 v[112:127], v[128:131], v[132:135], v[112:127]
  s_cmp_eq_u32 s2, 0
  s_cselect_b32 s58, 0, 1073741824
  v_or_b32 v248, s58, v3
  s_mov_b32 s58, 753664
  buffer_store_dword v4, v248, s[44:47], s58 offen sc1
  v_mfma_f32_32x32x16_bf16 v[112:127], v[176:179], v[180:183], v[112:127]
  v_mfma_f32_32x32x16_bf16 v[208:223], v[188:191], v[184:187], v[208:223]
  s_setprio 0
  v_exp_f32 v16, v16
  s_setprio 1
  v_exp_f32 v17, v17
  v_exp_f32 v18, v18
  v_exp_f32 v19, v19
  v_exp_f32 v20, v20
  v_exp_f32 v21, v21
  v_exp_f32 v22, v22
  v_exp_f32 v23, v23
  v_exp_f32 v24, v24
  v_exp_f32 v25, v25
  v_exp_f32 v26, v26
  v_exp_f32 v27, v27
  v_exp_f32 v28, v28
  v_exp_f32 v29, v29
  v_exp_f32 v30, v30
  v_exp_f32 v31, v31
  v_exp_f32 v32, v32
  v_exp_f32 v33, v33
  v_exp_f32 v34, v34
  v_exp_f32 v35, v35
  v_exp_f32 v36, v36
  v_exp_f32 v37, v37
  v_exp_f32 v38, v38
  v_exp_f32 v39, v39
  v_exp_f32 v40, v40
  v_exp_f32 v41, v41
  v_exp_f32 v42, v42
  v_exp_f32 v43, v43
  v_exp_f32 v44, v44
  v_exp_f32 v45, v45
  s_waitcnt vmcnt(6)
  v_exp_f32 v46, v46
  v_exp_f32 v47, v47
  s_setprio 3
  s_waitcnt lgkmcnt(0)
  v_smfmac_f32_32x32x32_bf16 v[48:63], v[96:99], v[16:23], v5
  s_barrier
  ds_read_b128 v[128:131], v228 offset:16384
  ds_read_b64_tr_b16 v[132:133], v9 offset:16384
  ds_read_b64_tr_b16 v[134:135], v9 offset:16896
  v_smfmac_f32_32x32x32_bf16 v[48:63], v[100:103], v[24:31], v5
  ds_read_b128 v[176:179], v229 offset:16384
  ds_read_b64_tr_b16 v[180:181], v9 offset:18432
  ds_read_b64_tr_b16 v[182:183], v9 offset:18944
  v_smfmac_f32_32x32x32_bf16 v[64:79], v[100:103], v[40:47], v5
  ds_read_b128 v[184:187], v224 offset:16384
  ds_read_b64_tr_b16 v[188:189], v8 offset:24576
  ds_read_b64_tr_b16 v[190:191], v8 offset:25088
  v_smfmac_f32_32x32x32_bf16 v[64:79], v[96:99], v[32:39], v5
  s_mov_b64 exec, s[52:53]
  ds_read_b128 v[104:107], v7 offset:28672
  ds_read_b128 v[108:111], v7 offset:29184
  s_mov_b64 exec, -1
  buffer_load_dword v246, v246, s[44:47], 0 offen sc1
  v_mfma_f32_32x32x16_bf16 v[16:31], v[92:95], v[80:83], 0
  ds_read_b128 v[88:91], v6 offset:0
  s_add_u32 m0, s57, 81920
  s_mov_b32 s58, 384
  buffer_load_dwordx4 v10, s[24:27], s58 offen lds
  v_mfma_f32_32x32x16_bf16 v[32:47], v[92:95], v[84:87], 0
  s_add_u32 m0, s57, 90112
L_padstart0:
L_pad0:
  s_cbranch_execz L_pad3
  s_mov_b32 s58, 65920
  buffer_load_dwordx4 v10, s[24:27], s58 offen lds
  s_waitcnt lgkmcnt(3)
  v_mfma_f32_32x32x16_bf16 v[112:127], v[128:131], v[132:135], v[112:127]
  v_mfma_f32_32x32x16_bf16 v[112:127], v[176:179], v[180:183], v[112:127]
  v_mfma_f32_32x32x16_bf16 v[208:223], v[188:191], v[184:187], v[208:223]
  s_setprio 0
  v_exp_f32 v16, v16
  s_setprio 1
  v_exp_f32 v17, v17
  v_exp_f32 v18, v18
  v_exp_f32 v19, v19
  v_exp_f32 v20, v20
  v_exp_f32 v21, v21
  v_exp_f32 v22, v22
  v_exp_f32 v23, v23
  v_exp_f32 v24, v24
  v_exp_f32 v25, v25
  v_exp_f32 v26, v26
  v_exp_f32 v27, v27
  v_exp_f32 v28, v28
  v_exp_f32 v29, v29
  v_exp_f32 v30, v30
  v_exp_f32 v31, v31
  v_exp_f32 v32, v32
  v_exp_f32 v33, v33
  v_exp_f32 v34, v34
  v_exp_f32 v35, v35
  v_exp_f32 v36, v36
  v_exp_f32 v37, v37
  v_exp_f32 v38, v38
  v_exp_f32 v39, v39
  v_exp_f32 v40, v40
  v_exp_f32 v41, v41
  v_exp_f32 v42, v42
  v_exp_f32 v43, v43
  v_exp_f32 v44, v44
  v_exp_f32 v45, v45
  v_exp_f32 v46, v46
  v_exp_f32 v47, v47
  s_setprio 3
  s_waitcnt lgkmcnt(0)
  v_smfmac_f32_32x32x32_bf16 v[48:63], v[104:107], v[16:23], v5
  ds_read_b128 v[128:131], v230 offset:16384
  ds_read_b64_tr_b16 v[132:133], v9 offset:20480
  ds_read_b64_tr_b16 v[134:135], v9 offset:20992
  v_smfmac_f32_32x32x32_bf16 v[48:63], v[108:111], v[24:31], v5
  ds_read_b128 v[176:179], v231 offset:16384
  ds_read_b64_tr_b16 v[180:181], v9 offset:22528
  ds_read_b64_tr_b16 v[182:183], v9 offset:23040
  v_smfmac_f32_32x32x32_bf16 v[64:79], v[108:111], v[40:47], v5
  ds_read_b128 v[184:187], v225 offset:16384
  ds_read_b64_tr_b16 v[188:189], v8 offset:26624
  ds_read_b64_tr_b16 v[190:191], v8 offset:27136
  v_smfmac_f32_32x32x32_bf16 v[64:79], v[104:107], v[32:39], v5
  s_mov_b64 exec, s[52:53]
  ds_read_b128 v[96:99], v7 offset:0
  ds_read_b128 v[100:103], v7 offset:512
  s_mov_b64 exec, -1
  s_add_u32 m0, s57, 16384
  s_mov_b32 s58, 49152
  buffer_load_dwordx4 v14, s[44:47], s58 offen sc1 lds
  v_mfma_f32_32x32x16_bf16 v[16:31], v[88:91], v[80:83], 0
  ds_read_b128 v[92:95], v6 offset:4096
  s_add_u32 m0, s57, 147456
  s_mov_b32 s58, 589824
  buffer_load_dwordx4 v12, s[28:31], s58 offen lds
  v_mfma_f32_32x32x16_bf16 v[32:47], v[88:91], v[84:87], 0
  s_add_u32 m0, s57, 155648
  s_mov_b32 s58, 589824
  buffer_load_dwordx4 v11, s[28:31], s58 offen lds
  s_waitcnt lgkmcnt(3)
  v_mfma_f32_32x32x16_bf16 v[112:127], v[128:131], v[132:135], v[112:127]
  v_mfma_f32_32x32x16_bf16 v[112:127], v[176:179], v[180:183], v[112:127]
  v_mfma_f32_32x32x16_bf16 v[208:223], v[188:191], v[184:187], v[208:223]
  s_setprio 0
  v_exp_f32 v16, v16
  s_setprio 1
  v_exp_f32 v17, v17
  v_exp_f32 v18, v18
  v_exp_f32 v19, v19
  v_exp_f32 v20, v20
  v_exp_f32 v21, v21
  v_exp_f32 v22, v22
  v_exp_f32 v23, v23
  v_exp_f32 v24, v24
  v_exp_f32 v25, v25
  v_exp_f32 v26, v26
  v_exp_f32 v27, v27
  v_exp_f32 v28, v28
  v_exp_f32 v29, v29
  v_exp_f32 v30, v30
  v_exp_f32 v31, v31
  v_exp_f32 v32, v32
  v_exp_f32 v33, v33
  v_exp_f32 v34, v34
  v_exp_f32 v35, v35
  v_exp_f32 v36, v36
  v_exp_f32 v37, v37
  v_exp_f32 v38, v38
  v_exp_f32 v39, v39
  v_exp_f32 v40, v40
  v_exp_f32 v41, v41
  v_exp_f32 v42, v42
  v_exp_f32 v43, v43
  v_exp_f32 v44, v44
  v_exp_f32 v45, v45
  s_waitcnt vmcnt(7)
  v_exp_f32 v46, v46
  v_exp_f32 v47, v47
  s_setprio 3
  s_waitcnt lgkmcnt(0)
  v_smfmac_f32_32x32x32_bf16 v[48:63], v[96:99], v[16:23], v5
  s_barrier
  ds_read_b128 v[128:131], v228 offset:32768
  ds_read_b64_tr_b16 v[132:133], v9 offset:32768
  ds_read_b64_tr_b16 v[134:135], v9 offset:33280
  v_smfmac_f32_32x32x32_bf16 v[48:63], v[100:103], v[24:31], v5
  ds_read_b128 v[176:179], v229 offset:32768
  ds_read_b64_tr_b16 v[180:181], v9 offset:34816
  ds_read_b64_tr_b16 v[182:183], v9 offset:35328
  v_smfmac_f32_32x32x32_bf16 v[64:79], v[100:103], v[40:47], v5
  ds_read_b128 v[184:187], v224 offset:32768
  ds_read_b64_tr_b16 v[188:189], v8 offset:40960
  ds_read_b64_tr_b16 v[190:191], v8 offset:41472
  v_smfmac_f32_32x32x32_bf16 v[64:79], v[96:99], v[32:39], v5
  s_mov_b64 exec, s[52:53]
  ds_read_b128 v[104:107], v7 offset:4096
  ds_read_b128 v[108:111], v7 offset:4608
  s_mov_b64 exec, -1
  buffer_store_dwordx4 v[136:139], v245, s[44:47], s74 offen sc1
  v_mfma_f32_32x32x16_bf16 v[16:31], v[92:95], v[80:83], 0
  ds_read_b128 v[88:91], v6 offset:8192
  s_add_u32 m0, s57, 32768
  s_mov_b32 s58, 512
  buffer_load_dwordx4 v10, s[24:27], s58 offen lds
  v_mfma_f32_32x32x16_bf16 v[32:47], v[92:95], v[84:87], 0
  s_add_u32 m0, s57, 40960
  s_mov_b32 s58, 66048
  buffer_load_dwordx4 v10, s[24:27], s58 offen lds
  s_waitcnt lgkmcnt(3)
  v_mfma_f32_32x32x16_bf16 v[112:127], v[128:131], v[132:135], v[112:127]
  v_mfma_f32_32x32x16_bf16 v[112:127], v[176:179], v[180:183], v[112:127]
  v_mfma_f32_32x32x16_bf16 v[208:223], v[188:191], v[184:187], v[208:223]
  s_setprio 0
  v_exp_f32 v16, v16
  s_setprio 1
  v_exp_f32 v17, v17
  v_exp_f32 v18, v18
  v_exp_f32 v19, v19
  v_exp_f32 v20, v20
  v_exp_f32 v21, v21
  v_exp_f32 v22, v22
  v_exp_f32 v23, v23
  v_exp_f32 v24, v24
  v_exp_f32 v25, v25
  v_exp_f32 v26, v26
  v_exp_f32 v27, v27
  s_setprio 2
  s_waitcnt vmcnt(8)
  v_and_b32 v246, 15, v246
  v_cmp_ne_u32 vcc, s71, v246
  v_exp_f32 v28, v28
  v_exp_f32 v29, v29
  v_exp_f32 v30, v30
  v_exp_f32 v31, v31
  v_exp_f32 v32, v32
  v_exp_f32 v33, v33
  v_exp_f32 v34, v34
  v_exp_f32 v35, v35
  v_exp_f32 v36, v36
  v_exp_f32 v37, v37
  v_exp_f32 v38, v38
  v_exp_f32 v39, v39
  v_exp_f32 v40, v40
  v_exp_f32 v41, v41
  v_exp_f32 v42, v42
  v_exp_f32 v43, v43
  v_exp_f32 v44, v44
  v_exp_f32 v45, v45
  v_exp_f32 v46, v46
  v_exp_f32 v47, v47
  s_setprio 3
  s_waitcnt lgkmcnt(0)
  v_smfmac_f32_32x32x32_bf16 v[48:63], v[104:107], v[16:23], v5
  s_or_b32 s72, vcc_lo, 0
  s_cselect_b32 s72, -1, 0
  s_and_b32 s58, s72, 1073741824
  v_or_b32 v246, s58, v2
  ds_read_b128 v[128:131], v230 offset:32768
  ds_read_b64_tr_b16 v[132:133], v9 offset:36864
  ds_read_b64_tr_b16 v[134:135], v9 offset:37376
  v_smfmac_f32_32x32x32_bf16 v[48:63], v[108:111], v[24:31], v5
  ds_read_b128 v[176:179], v231 offset:32768
  ds_read_b64_tr_b16 v[180:181], v9 offset:38912
  ds_read_b64_tr_b16 v[182:183], v9 offset:39424
  v_smfmac_f32_32x32x32_bf16 v[64:79], v[108:111], v[40:47], v5
  ds_read_b128 v[184:187], v225 offset:32768
  ds_read_b64_tr_b16 v[188:189], v8 offset:43008
  ds_read_b64_tr_b16 v[190:191], v8 offset:43520
  v_smfmac_f32_32x32x32_bf16 v[64:79], v[104:107], v[32:39], v5
  s_mov_b64 exec, s[52:53]
  ds_read_b128 v[96:99], v7 offset:8192
  ds_read_b128 v[100:103], v7 offset:8704
  s_mov_b64 exec, -1
  s_add_u32 m0, s57, 24576
  s_mov_b32 s58, 57344
  buffer_load_dwordx4 v14, s[44:47], s58 offen sc1 lds
  v_mfma_f32_32x32x16_bf16 v[16:31], v[88:91], v[80:83], 0
  ds_read_b128 v[92:95], v6 offset:12288
  s_add_u32 m0, s57, 98304
  s_mov_b32 s58, 786432
  buffer_load_dwordx4 v12, s[28:31], s58 offen lds
  v_mfma_f32_32x32x16_bf16 v[32:47], v[88:91], v[84:87], 0
  s_add_u32 m0, s57, 106496
  s_mov_b32 s58, 786432
  buffer_load_dwordx4 v11, s[28:31], s58 offen lds
  s_waitcnt lgkmcnt(3)
  v_mfma_f32_32x32x16_bf16 v[112:127], v[128:131], v[132:135], v[112:127]
  v_mfma_f32_32x32x16_bf16 v[112:127], v[176:179], v[180:183], v[112:127]
  v_mfma_f32_32x32x16_bf16 v[208:223], v[188:191], v[184:187], v[208:223]
  s_setprio 0
  v_exp_f32 v16, v16
  s_setprio 1
  v_exp_f32 v17, v17
  v_exp_f32 v18, v18
  v_exp_f32 v19, v19
  v_exp_f32 v20, v20
  v_exp_f32 v21, v21
  v_exp_f32 v22, v22
  v_exp_f32 v23, v23
  v_exp_f32 v24, v24
  v_exp_f32 v25, v25
  v_exp_f32 v26, v26
  v_exp_f32 v27, v27
  v_exp_f32 v28, v28
  v_exp_f32 v29, v29
  v_exp_f32 v30, v30
  v_exp_f32 v31, v31
  v_exp_f32 v32, v32
  v_exp_f32 v33, v33
  v_exp_f32 v34, v34
  v_exp_f32 v35, v35
  v_exp_f32 v36, v36
  v_exp_f32 v37, v37
  v_exp_f32 v38, v38
  v_exp_f32 v39, v39
  v_exp_f32 v40, v40
  v_exp_f32 v41, v41
  v_exp_f32 v42, v42
  v_exp_f32 v43, v43
  v_exp_f32 v44, v44
  v_exp_f32 v45, v45
  s_waitcnt vmcnt(6)
  v_exp_f32 v46, v46
  v_exp_f32 v47, v47
  s_setprio 3
  s_waitcnt lgkmcnt(0)
  v_smfmac_f32_32x32x32_bf16 v[48:63], v[96:99], v[16:23], v5
  s_barrier
  ds_read_b128 v[128:131], v228 offset:49152
  ds_read_b64_tr_b16 v[132:133], v9 offset:49152
  ds_read_b64_tr_b16 v[134:135], v9 offset:49664
  v_smfmac_f32_32x32x32_bf16 v[48:63], v[100:103], v[24:31], v5
  ds_read_b128 v[176:179], v229 offset:49152
  ds_read_b64_tr_b16 v[180:181], v9 offset:51200
  ds_read_b64_tr_b16 v[182:183], v9 offset:51712
  v_smfmac_f32_32x32x32_bf16 v[64:79], v[100:103], v[40:47], v5
  ds_read_b128 v[184:187], v224 offset:49152
  ds_read_b64_tr_b16 v[188:189], v8 offset:57344
  ds_read_b64_tr_b16 v[190:191], v8 offset:57856
  v_smfmac_f32_32x32x32_bf16 v[64:79], v[96:99], v[32:39], v5
  s_mov_b64 exec, s[52:53]
  ds_read_b128 v[104:107], v7 offset:12288
  ds_read_b128 v[108:111], v7 offset:12800
  s_mov_b64 exec, -1
  s_mov_b32 s58, 1048576
  s_cmp_lg_u32 s72, 0
  s_cbranch_scc1 L_far_ca0
  buffer_store_dwordx4 v[136:139], v236, s[44:47], s58 offen
L_near_ca0:
  v_mfma_f32_32x32x16_bf16 v[16:31], v[92:95], v[80:83], 0
  ds_read_b128 v[88:91], v6 offset:16384
  s_add_u32 m0, s57, 49152
  s_mov_b32 s58, 640
  buffer_load_dwordx4 v10, s[24:27], s58 offen lds
  v_mfma_f32_32x32x16_bf16 v[32:47], v[92:95], v[84:87], 0
  s_add_u32 m0, s57, 57344
  s_mov_b32 s58, 66176
  buffer_load_dwordx4 v10, s[24:27], s58 offen lds
  s_waitcnt lgkmcnt(3)
  v_mfma_f32_32x32x16_bf16 v[112:127], v[128:131], v[132:135], v[112:127]
  v_mfma_f32_32x32x16_bf16 v[112:127], v[176:179], v[180:183], v[112:127]
  v_mfma_f32_32x32x16_bf16 v[208:223], v[188:191], v[184:187], v[208:223]
  s_setprio 0
  v_exp_f32 v16, v16
  s_setprio 1
  v_exp_f32 v17, v17
  v_exp_f32 v18, v18
  v_exp_f32 v19, v19
  v_exp_f32 v20, v20
  v_exp_f32 v21, v21
  v_exp_f32 v22, v22
  v_exp_f32 v23, v23
  v_exp_f32 v24, v24
  v_exp_f32 v25, v25
  v_exp_f32 v26, v26
  v_exp_f32 v27, v27
  v_exp_f32 v28, v28
  v_exp_f32 v29, v29
  v_exp_f32 v30, v30
  v_exp_f32 v31, v31
  v_exp_f32 v32, v32
  v_exp_f32 v33, v33
  v_exp_f32 v34, v34
  v_exp_f32 v35, v35
  v_exp_f32 v36, v36
  v_exp_f32 v37, v37
  v_exp_f32 v38, v38
  v_exp_f32 v39, v39
  v_exp_f32 v40, v40
  v_exp_f32 v41, v41
  v_exp_f32 v42, v42
  v_exp_f32 v43, v43
  v_exp_f32 v44, v44
  v_exp_f32 v45, v45
  v_exp_f32 v46, v46
  v_exp_f32 v47, v47
  s_setprio 3
  s_waitcnt lgkmcnt(0)
  v_smfmac_f32_32x32x32_bf16 v[48:63], v[104:107], v[16:23], v5
  ds_read_b128 v[128:131], v230 offset:49152
  ds_read_b64_tr_b16 v[132:133], v9 offset:53248
  ds_read_b64_tr_b16 v[134:135], v9 offset:53760
  v_smfmac_f32_32x32x32_bf16 v[48:63], v[108:111], v[24:31], v5
  ds_read_b128 v[176:179], v231 offset:49152
  ds_read_b64_tr_b16 v[180:181], v9 offset:55296
  ds_read_b64_tr_b16 v[182:183], v9 offset:55808
  v_smfmac_f32_32x32x32_bf16 v[64:79], v[108:111], v[40:47], v5
  ds_read_b128 v[184:187], v225 offset:49152
  ds_read_b64_tr_b16 v[188:189], v8 offset:59392
  ds_read_b64_tr_b16 v[190:191], v8 offset:59904
  v_smfmac_f32_32x32x32_bf16 v[64:79], v[104:107], v[32:39], v5
  s_mov_b64 exec, s[52:53]
  ds_read_b128 v[96:99], v7 offset:16384
  ds_read_b128 v[100:103], v7 offset:16896
  s_mov_b64 exec, -1
  s_add_u32 m0, s57, 0
  s_mov_b32 s58, 65536
  buffer_load_dwordx4 v14, s[44:47], s58 offen sc1 lds
  v_mfma_f32_32x32x16_bf16 v[16:31], v[88:91], v[80:83], 0
  ds_read_b128 v[92:95], v6 offset:20480
  s_add_u32 m0, s57, 114688
  s_mov_b32 s58, 983040
  buffer_load_dwordx4 v12, s[28:31], s58 offen lds
  v_mfma_f32_32x32x16_bf16 v[32:47], v[88:91], v[84:87], 0
  s_add_u32 m0, s57, 122880
  s_mov_b32 s58, 983040
  buffer_load_dwordx4 v11, s[28:31], s58 offen lds
  s_waitcnt lgkmcnt(3)
  v_mfma_f32_32x32x16_bf16 v[112:127], v[128:131], v[132:135], v[112:127]
  v_mfma_f32_32x32x16_bf16 v[112:127], v[176:179], v[180:183], v[112:127]
  v_mfma_f32_32x32x16_bf16 v[208:223], v[188:191], v[184:187], v[208:223]
  s_setprio 0
  v_exp_f32 v16, v16
  s_setprio 1
  v_exp_f32 v17, v17
  v_exp_f32 v18, v18
  v_exp_f32 v19, v19
  v_exp_f32 v20, v20
  v_exp_f32 v21, v21
  v_exp_f32 v22, v22
  v_exp_f32 v23, v23
  v_exp_f32 v24, v24
  v_exp_f32 v25, v25
  v_exp_f32 v26, v26
  v_exp_f32 v27, v27
  v_exp_f32 v28, v28
  v_exp_f32 v29, v29
  v_exp_f32 v30, v30
  v_exp_f32 v31, v31
  v_exp_f32 v32, v32
  v_exp_f32 v33, v33
  v_exp_f32 v34, v34
  v_exp_f32 v35, v35
  v_exp_f32 v36, v36
  v_exp_f32 v37, v37
  v_exp_f32 v38, v38
  v_exp_f32 v39, v39
  v_exp_f32 v40, v40
  v_exp_f32 v41, v41
  v_exp_f32 v42, v42
  v_exp_f32 v43, v43
  v_exp_f32 v44, v44
  v_exp_f32 v45, v45
  s_waitcnt vmcnt(6)
  v_exp_f32 v46, v46
  v_exp_f32 v47, v47
  s_setprio 3
  s_waitcnt lgkmcnt(0)
  v_smfmac_f32_32x32x32_bf16 v[48:63], v[96:99], v[16:23], v5
  s_barrier
  ds_read_b128 v[128:131], v228 offset:0
  ds_read_b64_tr_b16 v[132:133], v9 offset:0
  ds_read_b64_tr_b16 v[134:135], v9 offset:512
  v_smfmac_f32_32x32x32_bf16 v[48:63], v[100:103], v[24:31], v5
  ds_read_b128 v[176:179], v229 offset:0
  ds_read_b64_tr_b16 v[180:181], v9 offset:2048
  ds_read_b64_tr_b16 v[182:183], v9 offset:2560
  v_smfmac_f32_32x32x32_bf16 v[64:79], v[100:103], v[40:47], v5
  ds_read_b128 v[184:187], v224 offset:0
  ds_read_b64_tr_b16 v[188:189], v8 offset:8192
  ds_read_b64_tr_b16 v[190:191], v8 offset:8704
  v_smfmac_f32_32x32x32_bf16 v[64:79], v[96:99], v[32:39], v5
  s_mov_b64 exec, s[52:53]
  ds_read_b128 v[104:107], v7 offset:20480
  ds_read_b128 v[108:111], v7 offset:20992
  s_mov_b64 exec, -1
  s_mov_b32 s58, 3145728
  s_cmp_lg_u32 s72, 0
  s_cbranch_scc1 L_far_cb0
  buffer_store_dwordx4 v[136:139], v236, s[44:47], s58 offen
L_near_cb0:
  v_mfma_f32_32x32x16_bf16 v[16:31], v[92:95], v[80:83], 0
  ds_read_b128 v[88:91], v6 offset:24576
  s_add_u32 m0, s57, 65536
  s_mov_b32 s58, 768
  buffer_load_dwordx4 v10, s[24:27], s58 offen lds
  v_mfma_f32_32x32x16_bf16 v[32:47], v[92:95], v[84:87], 0
  s_add_u32 m0, s57, 73728
  s_mov_b32 s58, 66304
  buffer_load_dwordx4 v10, s[24:27], s58 offen lds
  s_waitcnt lgkmcnt(3)
  v_mfma_f32_32x32x16_bf16 v[112:127], v[128:131], v[132:135], v[112:127]
  v_mfma_f32_32x32x16_bf16 v[112:127], v[176:179], v[180:183], v[112:127]
  v_mfma_f32_32x32x16_bf16 v[208:223], v[188:191], v[184:187], v[208:223]
  s_setprio 0
  v_exp_f32 v16, v16
  s_setprio 1
  v_exp_f32 v17, v17
  v_exp_f32 v18, v18
  v_exp_f32 v19, v19
  v_exp_f32 v20, v20
  v_exp_f32 v21, v21
  v_exp_f32 v22, v22
  v_exp_f32 v23, v23
  v_exp_f32 v24, v24
  v_exp_f32 v25, v25
  v_exp_f32 v26, v26
  v_exp_f32 v27, v27
  v_exp_f32 v28, v28
  v_exp_f32 v29, v29
  v_exp_f32 v30, v30
  v_exp_f32 v31, v31
  v_exp_f32 v32, v32
  v_exp_f32 v33, v33
  v_exp_f32 v34, v34
  v_exp_f32 v35, v35
  v_exp_f32 v36, v36
  v_exp_f32 v37, v37
  v_exp_f32 v38, v38
  v_exp_f32 v39, v39
  v_exp_f32 v40, v40
  v_exp_f32 v41, v41
  v_exp_f32 v42, v42
  v_exp_f32 v43, v43
  v_exp_f32 v44, v44
  v_exp_f32 v45, v45
  v_exp_f32 v46, v46
  v_exp_f32 v47, v47
  s_setprio 3
  s_waitcnt lgkmcnt(0)
  v_smfmac_f32_32x32x32_bf16 v[48:63], v[104:107], v[16:23], v5
  ds_read_b128 v[128:131], v230 offset:0
  ds_read_b64_tr_b16 v[132:133], v9 offset:4096
  ds_read_b64_tr_b16 v[134:135], v9 offset:4608
  v_smfmac_f32_32x32x32_bf16 v[48:63], v[108:111], v[24:31], v5
  ds_read_b128 v[176:179], v231 offset:0
  ds_read_b64_tr_b16 v[180:181], v9 offset:6144
  ds_read_b64_tr_b16 v[182:183], v9 offset:6656
  v_smfmac_f32_32x32x32_bf16 v[64:79], v[108:111], v[40:47], v5
  ds_read_b128 v[184:187], v225 offset:0
  ds_read_b64_tr_b16 v[188:189], v8 offset:10240
  ds_read_b64_tr_b16 v[190:191], v8 offset:10752
  v_smfmac_f32_32x32x32_bf16 v[64:79], v[104:107], v[32:39], v5
  s_mov_b64 exec, s[52:53]
  ds_read_b128 v[96:99], v7 offset:24576
  ds_read_b128 v[100:103], v7 offset:25088
  s_mov_b64 exec, -1
  s_add_u32 m0, s57, 8192
  s_mov_b32 s58, 73728
  buffer_load_dwordx4 v14, s[44:47], s58 offen sc1 lds
  v_mfma_f32_32x32x16_bf16 v[16:31], v[88:91], v[80:83], 0
  ds_read_b128 v[92:95], v6 offset:28672
  s_add_u32 m0, s57, 131072
  s_mov_b32 s58, 1179648
  buffer_load_dwordx4 v12, s[28:31], s58 offen lds
  v_mfma_f32_32x32x16_bf16 v[32:47], v[88:91], v[84:87], 0
  s_add_u32 m0, s57, 139264
  s_mov_b32 s58, 1179648
  buffer_load_dwordx4 v11, s[28:31], s58 offen lds
  s_waitcnt lgkmcnt(3)
  v_mfma_f32_32x32x16_bf16 v[112:127], v[128:131], v[132:135], v[112:127]
  v_mfma_f32_32x32x16_bf16 v[112:127], v[176:179], v[180:183], v[112:127]
  v_mfma_f32_32x32x16_bf16 v[208:223], v[188:191], v[184:187], v[208:223]
  s_setprio 0
  v_exp_f32 v16, v16
  s_setprio 1
  v_exp_f32 v17, v17
  v_exp_f32 v18, v18
  v_exp_f32 v19, v19
  v_exp_f32 v20, v20
  v_exp_f32 v21, v21
  v_exp_f32 v22, v22
  v_exp_f32 v23, v23
  v_exp_f32 v24, v24
  v_exp_f32 v25, v25
  v_exp_f32 v26, v26
  v_exp_f32 v27, v27
  v_exp_f32 v28, v28
  v_exp_f32 v29, v29
  v_exp_f32 v30, v30
  v_exp_f32 v31, v31
  v_exp_f32 v32, v32
  v_exp_f32 v33, v33
  v_exp_f32 v34, v34
  v_exp_f32 v35, v35
  v_exp_f32 v36, v36
  v_exp_f32 v37, v37
  v_exp_f32 v38, v38
  v_exp_f32 v39, v39
  v_exp_f32 v40, v40
  v_exp_f32 v41, v41
  v_exp_f32 v42, v42
  v_exp_f32 v43, v43
  v_exp_f32 v44, v44
  v_exp_f32 v45, v45
  s_waitcnt vmcnt(5)
  v_exp_f32 v46, v46
  v_exp_f32 v47, v47
  s_setprio 3
  s_waitcnt lgkmcnt(0)
  v_smfmac_f32_32x32x32_bf16 v[48:63], v[96:99], v[16:23], v5
  s_barrier
  ds_read_b128 v[128:131], v228 offset:16384
  ds_read_b64_tr_b16 v[132:133], v9 offset:16384
  ds_read_b64_tr_b16 v[134:135], v9 offset:16896
  v_smfmac_f32_32x32x32_bf16 v[48:63], v[100:103], v[24:31], v5
  ds_read_b128 v[176:179], v229 offset:16384
  ds_read_b64_tr_b16 v[180:181], v9 offset:18432
  ds_read_b64_tr_b16 v[182:183], v9 offset:18944
  v_smfmac_f32_32x32x32_bf16 v[64:79], v[100:103], v[40:47], v5
  ds_read_b128 v[184:187], v224 offset:16384
  ds_read_b64_tr_b16 v[188:189], v8 offset:24576
  ds_read_b64_tr_b16 v[190:191], v8 offset:25088
  v_smfmac_f32_32x32x32_bf16 v[64:79], v[96:99], v[32:39], v5
  s_mov_b64 exec, s[52:53]
  ds_read_b128 v[104:107], v7 offset:28672
  ds_read_b128 v[108:111], v7 offset:29184
  s_mov_b64 exec, -1
  s_add_u32 s58, s70, 65536
  buffer_store_dword v4, v3, s[44:47], s58 offen sc1
  v_mfma_f32_32x32x16_bf16 v[16:31], v[92:95], v[80:83], 0
  ds_read_b128 v[88:91], v6 offset:0
  s_add_u32 m0, s57, 81920
  s_mov_b32 s58, 896
  buffer_load_dwordx4 v10, s[24:27], s58 offen lds
  v_mfma_f32_32x32x16_bf16 v[32:47], v[92:95], v[84:87], 0
  s_add_u32 m0, s57, 90112
  s_mov_b32 s58, 66432
  buffer_load_dwordx4 v10, s[24:27], s58 offen lds
  s_waitcnt lgkmcnt(3)
  v_mfma_f32_32x32x16_bf16 v[112:127], v[128:131], v[132:135], v[112:127]
  v_mfma_f32_32x32x16_bf16 v[112:127], v[176:179], v[180:183], v[112:127]
  v_mfma_f32_32x32x16_bf16 v[208:223], v[188:191], v[184:187], v[208:223]
  s_setprio 0
  v_exp_f32 v16, v16
  s_setprio 1
  v_exp_f32 v17, v17
  v_exp_f32 v18, v18
  v_exp_f32 v19, v19
  v_exp_f32 v20, v20
  v_exp_f32 v21, v21
  v_exp_f32 v22, v22
  v_exp_f32 v23, v23
  v_exp_f32 v24, v24
  v_exp_f32 v25, v25
  v_exp_f32 v26, v26
  v_exp_f32 v27, v27
  v_exp_f32 v28, v28
  v_exp_f32 v29, v29
  v_exp_f32 v30, v30
  v_exp_f32 v31, v31
  v_exp_f32 v32, v32
  v_exp_f32 v33, v33
  v_exp_f32 v34, v34
  v_exp_f32 v35, v35
  v_exp_f32 v36, v36
  v_exp_f32 v37, v37
  v_exp_f32 v38, v38
  v_exp_f32 v39, v39
  v_exp_f32 v40, v40
  v_exp_f32 v41, v41
  v_exp_f32 v42, v42
  v_exp_f32 v43, v43
  v_exp_f32 v44, v44
  v_exp_f32 v45, v45
  v_exp_f32 v46, v46
  v_exp_f32 v47, v47
  s_setprio 3
  s_waitcnt lgkmcnt(0)
  v_smfmac_f32_32x32x32_bf16 v[48:63], v[104:107], v[16:23], v5
  ds_read_b128 v[128:131], v230 offset:16384
  ds_read_b64_tr_b16 v[132:133], v9 offset:20480
  ds_read_b64_tr_b16 v[134:135], v9 offset:20992
  v_smfmac_f32_32x32x32_bf16 v[48:63], v[108:111], v[24:31], v5
  ds_read_b128 v[176:179], v231 offset:16384
  ds_read_b64_tr_b16 v[180:181], v9 offset:22528
  ds_read_b64_tr_b16 v[182:183], v9 offset:23040
  v_smfmac_f32_32x32x32_bf16 v[64:79], v[108:111], v[40:47], v5
  ds_read_b128 v[184:187], v225 offset:16384
  ds_read_b64_tr_b16 v[188:189], v8 offset:26624
  ds_read_b64_tr_b16 v[190:191], v8 offset:27136
  v_smfmac_f32_32x32x32_bf16 v[64:79], v[104:107], v[32:39], v5
  s_mov_b64 exec, s[52:53]
  ds_read_b128 v[96:99], v7 offset:0
  ds_read_b128 v[100:103], v7 offset:512
  s_mov_b64 exec, -1
  s_add_u32 m0, s57, 16384
  s_mov_b32 s58, 81920
  buffer_load_dwordx4 v14, s[44:47], s58 offen sc1 lds
  v_mfma_f32_32x32x16_bf16 v[16:31], v[88:91], v[80:83], 0
  ds_read_b128 v[92:95], v6 offset:4096
  s_add_u32 m0, s57, 147456
  s_mov_b32 s58, 1376256
  buffer_load_dwordx4 v12, s[28:31], s58 offen lds
  v_mfma_f32_32x32x16_bf16 v[32:47], v[88:91], v[84:87], 0
  s_add_u32 m0, s57, 155648
  s_mov_b32 s58, 1376256
  buffer_load_dwordx4 v11, s[28:31], s58 offen lds
  s_waitcnt lgkmcnt(3)
  v_mfma_f32_32x32x16_bf16 v[112:127], v[128:131], v[132:135], v[112:127]
  v_mfma_f32_32x32x16_bf16 v[112:127], v[176:179], v[180:183], v[112:127]
  v_mfma_f32_32x32x16_bf16 v[208:223], v[188:191], v[184:187], v[208:223]
  s_setprio 0
  v_exp_f32 v16, v16
  s_setprio 1
  v_exp_f32 v17, v17
  v_exp_f32 v18, v18
  v_exp_f32 v19, v19
  v_exp_f32 v20, v20
  v_exp_f32 v21, v21
  v_exp_f32 v22, v22
  v_exp_f32 v23, v23
  v_exp_f32 v24, v24
  v_exp_f32 v25, v25
  v_exp_f32 v26, v26
  v_exp_f32 v27, v27
  v_exp_f32 v28, v28
  v_exp_f32 v29, v29
  v_exp_f32 v30, v30
  v_exp_f32 v31, v31
  v_exp_f32 v32, v32
  v_exp_f32 v33, v33
  v_exp_f32 v34, v34
  v_exp_f32 v35, v35
  v_exp_f32 v36, v36
  v_exp_f32 v37, v37
  v_exp_f32 v38, v38
  v_exp_f32 v39, v39
  v_exp_f32 v40, v40
  v_exp_f32 v41, v41
  v_exp_f32 v42, v42
  v_exp_f32 v43, v43
  v_exp_f32 v44, v44
  v_exp_f32 v45, v45
  s_waitcnt vmcnt(6)
  v_exp_f32 v46, v46
  v_exp_f32 v47, v47
  s_setprio 3
  s_waitcnt lgkmcnt(0)
  v_smfmac_f32_32x32x32_bf16 v[48:63], v[96:99], v[16:23], v5
  s_barrier
  ds_read_b128 v[128:131], v228 offset:32768
  ds_read_b64_tr_b16 v[132:133], v9 offset:32768
  ds_read_b64_tr_b16 v[134:135], v9 offset:33280
  v_smfmac_f32_32x32x32_bf16 v[48:63], v[100:103], v[24:31], v5
  ds_read_b128 v[176:179], v229 offset:32768
  ds_read_b64_tr_b16 v[180:181], v9 offset:34816
  ds_read_b64_tr_b16 v[182:183], v9 offset:35328
  v_smfmac_f32_32x32x32_bf16 v[64:79], v[100:103], v[40:47], v5
  ds_read_b128 v[184:187], v224 offset:32768
  ds_read_b64_tr_b16 v[188:189], v8 offset:40960
  ds_read_b64_tr_b16 v[190:191], v8 offset:41472
  v_smfmac_f32_32x32x32_bf16 v[64:79], v[96:99], v[32:39], v5
  s_mov_b64 exec, s[52:53]
  ds_read_b128 v[104:107], v7 offset:4096
  ds_read_b128 v[108:111], v7 offset:4608
  s_mov_b64 exec, -1
  v_mfma_f32_32x32x16_bf16 v[16:31], v[92:95], v[80:83], 0
  ds_read_b128 v[88:91], v6 offset:8192
  s_add_u32 m0, s57, 98304
  s_mov_b32 s58, 0
  buffer_load_dwordx4 v13, s[20:23], s58 offen lds
  v_mfma_f32_32x32x16_bf16 v[32:47], v[92:95], v[84:87], 0
  s_add_u32 m0, s57, 106496
  s_mov_b32 s58, 65536
  buffer_load_dwordx4 v13, s[20:23], s58 offen lds
  s_waitcnt lgkmcnt(3)
  v_mfma_f32_32x32x16_bf16 v[112:127], v[128:131], v[132:135], v[112:127]
  v_mfma_f32_32x32x16_bf16 v[112:127], v[176:179], v[180:183], v[112:127]
  v_mfma_f32_32x32x16_bf16 v[208:223], v[188:191], v[184:187], v[208:223]
  s_setprio 0
  v_exp_f32 v16, v16
  s_setprio 1
  v_exp_f32 v17, v17
  v_exp_f32 v18, v18
  v_exp_f32 v19, v19
  v_exp_f32 v20, v20
  v_exp_f32 v21, v21
  v_exp_f32 v22, v22
  v_exp_f32 v23, v23
  v_exp_f32 v24, v24
  v_exp_f32 v25, v25
  v_exp_f32 v26, v26
  v_exp_f32 v27, v27
  v_exp_f32 v28, v28
  v_exp_f32 v29, v29
  v_exp_f32 v30, v30
  v_exp_f32 v31, v31
L_padstart1:
L_pad1:
  s_cbranch_execz L_pad4
  s_setprio 2
  v_exp_f32 v32, v32
  v_exp_f32 v33, v33
  v_exp_f32 v34, v34
  v_exp_f32 v35, v35
  v_exp_f32 v36, v36
  v_exp_f32 v37, v37
  v_exp_f32 v38, v38
  v_exp_f32 v39, v39
  v_exp_f32 v40, v40
  v_exp_f32 v41, v41
  v_exp_f32 v42, v42
  v_exp_f32 v43, v43
  v_exp_f32 v44, v44
  v_exp_f32 v45, v45
  v_exp_f32 v46, v46
  v_exp_f32 v47, v47
  s_setprio 3
  s_waitcnt lgkmcnt(0)
  v_smfmac_f32_32x32x32_bf16 v[48:63], v[104:107], v[16:23], v5
  ds_read_b128 v[128:131], v230 offset:32768
  ds_read_b64_tr_b16 v[132:133], v9 offset:36864
  ds_read_b64_tr_b16 v[134:135], v9 offset:37376
  v_smfmac_f32_32x32x32_bf16 v[48:63], v[108:111], v[24:31], v5
  ds_read_b128 v[176:179], v231 offset:32768
  ds_read_b64_tr_b16 v[180:181], v9 offset:38912
  ds_read_b64_tr_b16 v[182:183], v9 offset:39424
  v_smfmac_f32_32x32x32_bf16 v[64:79], v[108:111], v[40:47], v5
  ds_read_b128 v[184:187], v225 offset:32768
  ds_read_b64_tr_b16 v[188:189], v8 offset:43008
  ds_read_b64_tr_b16 v[190:191], v8 offset:43520
  v_smfmac_f32_32x32x32_bf16 v[64:79], v[104:107], v[32:39], v5
  s_mov_b64 exec, s[52:53]
  ds_read_b128 v[96:99], v7 offset:8192
  ds_read_b128 v[100:103], v7 offset:8704
  s_mov_b64 exec, -1
  s_add_u32 m0, s57, 24576
  s_mov_b32 s58, 90112
  buffer_load_dwordx4 v14, s[44:47], s58 offen sc1 lds
  v_mfma_f32_32x32x16_bf16 v[16:31], v[88:91], v[80:83], 0
  ds_read_b128 v[92:95], v6 offset:12288
  s_add_u32 m0, s57, 32768
  s_mov_b32 s58, 0
  buffer_load_dwordx4 v13, s[32:35], s58 offen lds
  v_mfma_f32_32x32x16_bf16 v[32:47], v[88:91], v[84:87], 0
  s_add_u32 m0, s57, 40960
  s_mov_b32 s58, 65536
  buffer_load_dwordx4 v13, s[32:35], s58 offen lds
  s_waitcnt lgkmcnt(3)
  v_mfma_f32_32x32x16_bf16 v[112:127], v[128:131], v[132:135], v[112:127]
  v_mfma_f32_32x32x16_bf16 v[112:127], v[176:179], v[180:183], v[112:127]
  v_mfma_f32_32x32x16_bf16 v[208:223], v[188:191], v[184:187], v[208:223]
  s_setprio 0
  v_exp_f32 v16, v16
  s_setprio 1
  v_exp_f32 v17, v17
  v_exp_f32 v18, v18
  v_exp_f32 v19, v19
  v_exp_f32 v20, v20
  v_exp_f32 v21, v21
  v_exp_f32 v22, v22
  v_exp_f32 v23, v23
  v_exp_f32 v24, v24
  v_exp_f32 v25, v25
  v_exp_f32 v26, v26
  v_exp_f32 v27, v27
  v_exp_f32 v28, v28
  v_exp_f32 v29, v29
  v_exp_f32 v30, v30
  v_exp_f32 v31, v31
  v_exp_f32 v32, v32
  v_exp_f32 v33, v33
  v_exp_f32 v34, v34
  v_exp_f32 v35, v35
  v_exp_f32 v36, v36
  v_exp_f32 v37, v37
  v_exp_f32 v38, v38
  v_exp_f32 v39, v39
  v_exp_f32 v40, v40
  v_exp_f32 v41, v41
  v_exp_f32 v42, v42
  v_exp_f32 v43, v43
  v_exp_f32 v44, v44
  v_exp_f32 v45, v45
  s_waitcnt vmcnt(5)
  v_exp_f32 v46, v46
  v_exp_f32 v47, v47
  s_setprio 3
  s_waitcnt lgkmcnt(0)
  v_smfmac_f32_32x32x32_bf16 v[48:63], v[96:99], v[16:23], v5
  s_barrier
  ds_read_b128 v[128:131], v228 offset:49152
  ds_read_b64_tr_b16 v[132:133], v9 offset:49152
  ds_read_b64_tr_b16 v[134:135], v9 offset:49664
  v_smfmac_f32_32x32x32_bf16 v[48:63], v[100:103], v[24:31], v5
  ds_read_b128 v[176:179], v229 offset:49152
  ds_read_b64_tr_b16 v[180:181], v9 offset:51200
  ds_read_b64_tr_b16 v[182:183], v9 offset:51712
  v_smfmac_f32_32x32x32_bf16 v[64:79], v[100:103], v[40:47], v5
  ds_read_b128 v[184:187], v224 offset:49152
  ds_read_b64_tr_b16 v[188:189], v8 offset:57344
  ds_read_b64_tr_b16 v[190:191], v8 offset:57856
  ds_read_b128 v[192:195], v225 offset:49152
  ds_read_b64_tr_b16 v[196:197], v8 offset:59392
  ds_read_b64_tr_b16 v[198:199], v8 offset:59904
  v_smfmac_f32_32x32x32_bf16 v[64:79], v[96:99], v[32:39], v5
  s_mov_b64 exec, s[52:53]
  ds_read_b128 v[104:107], v7 offset:12288
  ds_read_b128 v[108:111], v7 offset:12800
  s_mov_b64 exec, -1
  buffer_load_dword v247, v140, s[44:47], 0 offen sc1
  v_mfma_f32_32x32x16_bf16 v[16:31], v[92:95], v[80:83], 0
  ds_read_b128 v[88:91], v6 offset:16384
  s_add_u32 m0, s57, 114688
  s_mov_b32 s58, 131072
  buffer_load_dwordx4 v13, s[20:23], s58 offen lds
  v_mfma_f32_32x32x16_bf16 v[32:47], v[92:95], v[84:87], 0
  s_add_u32 m0, s57, 122880
  s_mov_b32 s58, 196608
  buffer_load_dwordx4 v13, s[20:23], s58 offen lds
  s_waitcnt lgkmcnt(12)
  v_mfma_f32_32x32x16_bf16 v[112:127], v[128:131], v[132:135], v[112:127]
  s_waitcnt lgkmcnt(9)
  v_mfma_f32_32x32x16_bf16 v[112:127], v[176:179], v[180:183], v[112:127]
  s_waitcnt lgkmcnt(3)
  v_mfma_f32_32x32x16_bf16 v[208:223], v[196:199], v[192:195], v[208:223]
  v_mfma_f32_32x32x16_bf16 v[208:223], v[188:191], v[184:187], v[208:223]
  s_setprio 0
  v_exp_f32 v16, v16
  s_setprio 1
  v_exp_f32 v17, v17
  v_exp_f32 v18, v18
  v_exp_f32 v19, v19
  v_exp_f32 v20, v20
  v_exp_f32 v21, v21
  v_exp_f32 v22, v22
  v_exp_f32 v23, v23
  v_exp_f32 v24, v24
  v_exp_f32 v25, v25
  v_exp_f32 v26, v26
  v_exp_f32 v27, v27
  v_exp_f32 v28, v28
  v_exp_f32 v29, v29
  v_exp_f32 v30, v30
  v_exp_f32 v31, v31
  v_exp_f32 v32, v32
  v_exp_f32 v33, v33
  v_exp_f32 v34, v34
  v_exp_f32 v35, v35
  v_exp_f32 v36, v36
  v_exp_f32 v37, v37
  v_exp_f32 v38, v38
  v_exp_f32 v39, v39
  v_exp_f32 v40, v40
  v_exp_f32 v41, v41
  v_exp_f32 v42, v42
  v_exp_f32 v43, v43
  v_exp_f32 v44, v44
  v_exp_f32 v45, v45
  v_exp_f32 v46, v46
  v_exp_f32 v47, v47
  s_setprio 3
  s_waitcnt lgkmcnt(0)
  v_smfmac_f32_32x32x32_bf16 v[48:63], v[104:107], v[16:23], v5
  ds_read_b128 v[128:131], v230 offset:49152
  ds_read_b64_tr_b16 v[132:133], v9 offset:53248
  ds_read_b64_tr_b16 v[134:135], v9 offset:53760
  v_smfmac_f32_32x32x32_bf16 v[48:63], v[108:111], v[24:31], v5
  ds_read_b128 v[176:179], v231 offset:49152
  ds_read_b64_tr_b16 v[180:181], v9 offset:55296
  ds_read_b64_tr_b16 v[182:183], v9 offset:55808
  v_smfmac_f32_32x32x32_bf16 v[64:79], v[108:111], v[40:47], v5
  ds_write_b128 v240, v[216:219]
  v_smfmac_f32_32x32x32_bf16 v[64:79], v[104:107], v[32:39], v5
  s_mov_b64 exec, s[52:53]
  ds_read_b128 v[96:99], v7 offset:16384
  ds_read_b128 v[100:103], v7 offset:16896
  s_mov_b64 exec, -1
  v_mfma_f32_32x32x16_bf16 v[16:31], v[88:91], v[80:83], 0
  ds_read_b128 v[92:95], v6 offset:20480
  v_mfma_f32_32x32x16_bf16 v[32:47], v[88:91], v[84:87], 0
  ds_write_b128 v240, v[220:223] offset:1024
  s_and_b32 s58, s2, -8
  s_add_u32 s58, s58, s3
  s_cmp_eq_u32 s58, 0
  s_cbranch_scc1 L_wb_P19
L_wbb_P19:
  s_waitcnt lgkmcnt(8)
  v_mfma_f32_32x32x16_bf16 v[112:127], v[128:131], v[132:135], v[112:127]
  s_waitcnt lgkmcnt(5)
  v_mfma_f32_32x32x16_bf16 v[112:127], v[176:179], v[180:183], v[112:127]
  s_setprio 0
  v_exp_f32 v16, v16
  s_setprio 1
  v_exp_f32 v17, v17
  v_exp_f32 v18, v18
  v_exp_f32 v19, v19
  v_exp_f32 v20, v20
  v_exp_f32 v21, v21
  v_exp_f32 v22, v22
  v_exp_f32 v23, v23
  v_exp_f32 v24, v24
  v_exp_f32 v25, v25
  v_exp_f32 v26, v26
  v_exp_f32 v27, v27
  s_setprio 2
  s_waitcnt vmcnt(2)
  v_xor_b32 v247, v247, v4
  v_cmp_lt_u32 vcc, 15, v247
  v_exp_f32 v28, v28
  v_exp_f32 v29, v29
  v_exp_f32 v30, v30
  v_exp_f32 v31, v31
  v_exp_f32 v32, v32
  v_exp_f32 v33, v33
  v_exp_f32 v34, v34
  v_exp_f32 v35, v35
  v_exp_f32 v36, v36
  v_exp_f32 v37, v37
  v_exp_f32 v38, v38
  v_exp_f32 v39, v39
  v_exp_f32 v40, v40
  v_exp_f32 v41, v41
  v_exp_f32 v42, v42
  v_exp_f32 v43, v43
  v_exp_f32 v44, v44
  v_exp_f32 v45, v45
  v_exp_f32 v46, v46
  v_exp_f32 v47, v47
  v_pk_mul_f32 v[248:249], v[112:113], s[12:13]
  v_pk_mul_f32 v[250:251], v[114:115], s[12:13]
  v_max_f32 v112, 0, v112
  v_max_f32 v113, 0, v113
  v_max_f32 v114, 0, v114
  v_max_f32 v115, 0, v115
  v_exp_f32_e64 v248, v248 clamp
  v_exp_f32_e64 v249, v249 clamp
  v_exp_f32_e64 v250, v250 clamp
  v_exp_f32_e64 v251, v251 clamp
  v_pk_add_f32 v[112:113], v[112:113], s[16:17]
  v_pk_add_f32 v[114:115], v[114:115], s[16:17]
  v_pk_add_f32 v[112:113], v[112:113], v[248:249]
  v_pk_add_f32 v[114:115], v[114:115], v[250:251]
  v_pk_mul_f32 v[248:249], v[116:117], s[12:13]
  v_pk_mul_f32 v[250:251], v[118:119], s[12:13]
  v_max_f32 v116, 0, v116
  v_max_f32 v117, 0, v117
  v_max_f32 v118, 0, v118
  v_max_f32 v119, 0, v119
  v_exp_f32_e64 v248, v248 clamp
  v_exp_f32_e64 v249, v249 clamp
  v_exp_f32_e64 v250, v250 clamp
  v_exp_f32_e64 v251, v251 clamp
  v_pk_add_f32 v[116:117], v[116:117], s[16:17]
  v_pk_add_f32 v[118:119], v[118:119], s[16:17]
  v_pk_add_f32 v[116:117], v[116:117], v[248:249]
  v_pk_add_f32 v[118:119], v[118:119], v[250:251]
  v_pk_mul_f32 v[248:249], v[120:121], s[12:13]
  v_pk_mul_f32 v[250:251], v[122:123], s[12:13]
  v_max_f32 v120, 0, v120
  v_max_f32 v121, 0, v121
  v_max_f32 v122, 0, v122
  v_max_f32 v123, 0, v123
  v_exp_f32_e64 v248, v248 clamp
  v_exp_f32_e64 v249, v249 clamp
  v_exp_f32_e64 v250, v250 clamp
  v_exp_f32_e64 v251, v251 clamp
  v_pk_add_f32 v[120:121], v[120:121], s[16:17]
  v_pk_add_f32 v[122:123], v[122:123], s[16:17]
  v_pk_add_f32 v[120:121], v[120:121], v[248:249]
  v_pk_add_f32 v[122:123], v[122:123], v[250:251]
  v_pk_mul_f32 v[248:249], v[124:125], s[12:13]
  v_pk_mul_f32 v[250:251], v[126:127], s[12:13]
  v_max_f32 v124, 0, v124
  v_max_f32 v125, 0, v125
  v_max_f32 v126, 0, v126
  v_max_f32 v127, 0, v127
  v_exp_f32_e64 v248, v248 clamp
  v_exp_f32_e64 v249, v249 clamp
  v_exp_f32_e64 v250, v250 clamp
  v_exp_f32_e64 v251, v251 clamp
  v_pk_add_f32 v[124:125], v[124:125], s[16:17]
  v_pk_add_f32 v[126:127], v[126:127], s[16:17]
  v_pk_add_f32 v[124:125], v[124:125], v[248:249]
  v_pk_add_f32 v[126:127], v[126:127], v[250:251]
  v_cvt_pk_bf16_f32 v112, v112, v113
  v_cvt_pk_bf16_f32 v113, v114, v115
  v_cvt_pk_bf16_f32 v114, v116, v117
  v_cvt_pk_bf16_f32 v115, v118, v119
  v_cvt_pk_bf16_f32 v116, v120, v121
  v_cvt_pk_bf16_f32 v117, v122, v123
  v_cvt_pk_bf16_f32 v118, v124, v125
  v_cvt_pk_bf16_f32 v119, v126, v127
  s_setprio 3
  s_waitcnt lgkmcnt(0)
  v_smfmac_f32_32x32x32_bf16 v[48:63], v[96:99], v[16:23], v5
  s_cbranch_vccnz L_spin_pc
L_back_pc:
  ds_write_b128 v240, v[112:115] offset:16384
  ds_write_b128 v240, v[116:119] offset:17408
  v_smfmac_f32_32x32x32_bf16 v[48:63], v[100:103], v[24:31], v5
  v_smfmac_f32_32x32x32_bf16 v[64:79], v[100:103], v[40:47], v5
  s_waitcnt lgkmcnt(0)
  s_barrier
  ds_read_b128 v[160:163], v238 offset:0
  ds_read_b128 v[164:167], v238 offset:1024
  s_mov_b64 exec, s[52:53]
  ds_read_b128 v[144:147], v239 offset:0
  ds_read_b128 v[148:151], v239 offset:1024
  s_mov_b64 exec, -1
  v_smfmac_f32_32x32x32_bf16 v[64:79], v[96:99], v[32:39], v5
  s_mov_b64 exec, s[52:53]
  ds_read_b128 v[104:107], v7 offset:20480
  ds_read_b128 v[108:111], v7 offset:20992
  s_mov_b64 exec, -1
  v_mfma_f32_32x32x16_bf16 v[16:31], v[92:95], v[80:83], 0
  ds_read_b128 v[88:91], v6 offset:24576
  ds_read_b128 v[168:171], v238 offset:2048
  ds_read_b128 v[172:175], v238 offset:3072
  s_mov_b64 exec, s[52:53]
  ds_read_b128 v[152:155], v239 offset:2048
  ds_read_b128 v[156:159], v239 offset:3072
  s_mov_b64 exec, -1
  v_mfma_f32_32x32x16_bf16 v[32:47], v[92:95], v[84:87], 0
  s_waitcnt lgkmcnt(8)
  v_mfma_f32_32x32x16_bf16 v[112:127], v[160:163], v[144:147], 0
  s_waitcnt lgkmcnt(7)
  v_mfma_f32_32x32x16_bf16 v[112:127], v[164:167], v[148:151], v[112:127]
  ds_read_b128 v[160:163], v238 offset:4096
  ds_read_b128 v[164:167], v238 offset:5120
  s_mov_b64 exec, s[52:53]
  ds_read_b128 v[144:147], v239 offset:4096
  ds_read_b128 v[148:151], v239 offset:5120
  s_mov_b64 exec, -1
  s_waitcnt lgkmcnt(5)
  v_mfma_f32_32x32x16_bf16 v[112:127], v[168:171], v[152:155], v[112:127]
  s_waitcnt lgkmcnt(4)
  v_mfma_f32_32x32x16_bf16 v[112:127], v[172:175], v[156:159], v[112:127]
  ds_read_b128 v[168:171], v238 offset:6144
  ds_read_b128 v[172:175], v238 offset:7168
  s_mov_b64 exec, s[52:53]
  ds_read_b128 v[152:155], v239 offset:6144
  ds_read_b128 v[156:159], v239 offset:7168
  s_mov_b64 exec, -1
  s_waitcnt lgkmcnt(5)
  v_mfma_f32_32x32x16_bf16 v[112:127], v[160:163], v[144:147], v[112:127]
  ds_read_b128 v[216:219], v241
  ds_read_b128 v[220:223], v241 offset:1024
  s_waitcnt lgkmcnt(6)
  v_mfma_f32_32x32x16_bf16 v[112:127], v[164:167], v[148:151], v[112:127]
  s_add_u32 m0, s57, 0
  s_mov_b32 s58, 98304
  buffer_load_dwordx4 v14, s[44:47], s58 offen sc1 lds
  s_waitcnt lgkmcnt(3)
  v_mfma_f32_32x32x16_bf16 v[112:127], v[168:171], v[152:155], v[112:127]
  s_waitcnt lgkmcnt(2)
  v_mfma_f32_32x32x16_bf16 v[112:127], v[172:175], v[156:159], v[112:127]
  s_setprio 0
  v_exp_f32 v16, v16
  s_setprio 1
  v_exp_f32 v17, v17
  v_exp_f32 v18, v18
  v_exp_f32 v19, v19
  v_exp_f32 v20, v20
  v_exp_f32 v21, v21
  v_exp_f32 v22, v22
  v_exp_f32 v23, v23
  v_exp_f32 v24, v24
  v_exp_f32 v25, v25
  v_exp_f32 v26, v26
  v_exp_f32 v27, v27
  s_setprio 2
  v_cvt_pk_bf16_f32 v112, v112, v113
  v_cvt_pk_bf16_f32 v113, v114, v115
  v_cvt_pk_bf16_f32 v114, v116, v117
  v_cvt_pk_bf16_f32 v115, v118, v119
  v_min_u32 v112, -2, v112
  buffer_store_dwordx4 v[112:115], v245, s[44:47], s74 offen sc1
  v_exp_f32 v28, v28
  v_exp_f32 v29, v29
  v_exp_f32 v30, v30
  v_exp_f32 v31, v31
  v_exp_f32 v32, v32
  v_exp_f32 v33, v33
  v_exp_f32 v34, v34
  v_exp_f32 v35, v35
  v_exp_f32 v36, v36
  v_exp_f32 v37, v37
  v_exp_f32 v38, v38
  v_exp_f32 v39, v39
  v_exp_f32 v40, v40
  v_exp_f32 v41, v41
  v_exp_f32 v42, v42
  v_exp_f32 v43, v43
  v_exp_f32 v44, v44
  v_exp_f32 v45, v45
  v_exp_f32 v46, v46
  v_exp_f32 v47, v47
  s_waitcnt lgkmcnt(1)
  v_pk_add_f32 v[208:209], v[208:209], v[216:217]
  v_pk_add_f32 v[210:211], v[210:211], v[218:219]
  s_waitcnt lgkmcnt(0)
  v_pk_add_f32 v[212:213], v[212:213], v[220:221]
  v_pk_add_f32 v[214:215], v[214:215], v[222:223]
  v_pk_mul_f32 v[248:249], v[208:209], s[12:13]
  v_pk_mul_f32 v[250:251], v[210:211], s[12:13]
  v_max_f32 v208, 0, v208
  v_max_f32 v209, 0, v209
  v_max_f32 v210, 0, v210
  v_max_f32 v211, 0, v211
  v_exp_f32_e64 v248, v248 clamp
  v_exp_f32_e64 v249, v249 clamp
  v_exp_f32_e64 v250, v250 clamp
  v_exp_f32_e64 v251, v251 clamp
  v_pk_add_f32 v[208:209], v[208:209], s[16:17]
  v_pk_add_f32 v[210:211], v[210:211], s[16:17]
  v_pk_add_f32 v[208:209], v[208:209], v[248:249]
  v_pk_add_f32 v[210:211], v[210:211], v[250:251]
  v_pk_mul_f32 v[248:249], v[212:213], s[12:13]
  v_pk_mul_f32 v[250:251], v[214:215], s[12:13]
  v_max_f32 v212, 0, v212
  v_max_f32 v213, 0, v213
  v_max_f32 v214, 0, v214
  v_max_f32 v215, 0, v215
  v_exp_f32_e64 v248, v248 clamp
  v_exp_f32_e64 v249, v249 clamp
  v_exp_f32_e64 v250, v250 clamp
  v_exp_f32_e64 v251, v251 clamp
  v_pk_add_f32 v[212:213], v[212:213], s[16:17]
  v_pk_add_f32 v[214:215], v[214:215], s[16:17]
  v_pk_add_f32 v[212:213], v[212:213], v[248:249]
  v_pk_add_f32 v[214:215], v[214:215], v[250:251]
  v_cvt_pk_bf16_f32 v136, v208, v209
  v_cvt_pk_bf16_f32 v137, v210, v211
  v_cvt_pk_bf16_f32 v138, v212, v213
  v_cvt_pk_bf16_f32 v139, v214, v215
  s_setprio 3
  v_smfmac_f32_32x32x32_bf16 v[48:63], v[104:107], v[16:23], v5
  v_smfmac_f32_32x32x32_bf16 v[48:63], v[108:111], v[24:31], v5
  v_smfmac_f32_32x32x32_bf16 v[64:79], v[108:111], v[40:47], v5
  v_smfmac_f32_32x32x32_bf16 v[64:79], v[104:107], v[32:39], v5
  s_mov_b64 exec, s[52:53]
  ds_read_b128 v[96:99], v7 offset:24576
  ds_read_b128 v[100:103], v7 offset:25088
  s_mov_b64 exec, -1
  s_add_u32 m0, s57, 8192
  s_mov_b32 s58, 106496
  buffer_load_dwordx4 v14, s[44:47], s58 offen sc1 lds
  v_mfma_f32_32x32x16_bf16 v[16:31], v[88:91], v[80:83], 0
  ds_read_b128 v[92:95], v6 offset:28672
  s_add_u32 m0, s57, 147456
  s_mov_b32 s58, 393216
  buffer_load_dwordx4 v13, s[20:23], s58 offen lds
  v_mfma_f32_32x32x16_bf16 v[32:47], v[88:91], v[84:87], 0
  s_add_u32 m0, s57, 155648
  s_mov_b32 s58, 458752
  buffer_load_dwordx4 v13, s[20:23], s58 offen lds
  s_nop 9
  s_setprio 0
  v_exp_f32 v16, v16
  s_setprio 1
  v_exp_f32 v17, v17
  v_exp_f32 v18, v18
  v_exp_f32 v19, v19
  v_exp_f32 v20, v20
  v_exp_f32 v21, v21
  v_exp_f32 v22, v22
  v_exp_f32 v23, v23
  v_exp_f32 v24, v24
  v_exp_f32 v25, v25
  v_exp_f32 v26, v26
  v_exp_f32 v27, v27
  v_exp_f32 v28, v28
  v_exp_f32 v29, v29
  v_exp_f32 v30, v30
  v_exp_f32 v31, v31
  v_exp_f32 v32, v32
  v_exp_f32 v33, v33
  v_exp_f32 v34, v34
  v_exp_f32 v35, v35
  v_exp_f32 v36, v36
  v_exp_f32 v37, v37
  v_exp_f32 v38, v38
  v_exp_f32 v39, v39
  v_exp_f32 v40, v40
  v_exp_f32 v41, v41
  v_exp_f32 v42, v42
  v_exp_f32 v43, v43
  v_exp_f32 v44, v44
  v_exp_f32 v45, v45
  s_waitcnt vmcnt(4)
  v_exp_f32 v46, v46
  v_exp_f32 v47, v47
  s_setprio 3
  s_waitcnt lgkmcnt(0)
  v_smfmac_f32_32x32x32_bf16 v[48:63], v[96:99], v[16:23], v5
  s_barrier
  v_smfmac_f32_32x32x32_bf16 v[48:63], v[100:103], v[24:31], v5
  v_smfmac_f32_32x32x32_bf16 v[64:79], v[100:103], v[40:47], v5
  v_smfmac_f32_32x32x32_bf16 v[64:79], v[96:99], v[32:39], v5
  s_mov_b64 exec, s[52:53]
  ds_read_b128 v[104:107], v7 offset:28672
  ds_read_b128 v[108:111], v7 offset:29184
  s_mov_b64 exec, -1
  v_mfma_f32_32x32x16_bf16 v[16:31], v[92:95], v[80:83], 0
  ds_read_b128 v[88:91], v6 offset:0
  s_add_u32 m0, s57, 139264
  s_mov_b32 s58, 327680
  buffer_load_dwordx4 v13, s[20:23], s58 offen lds
  v_mfma_f32_32x32x16_bf16 v[32:47], v[92:95], v[84:87], 0
  s_add_u32 m0, s57, 131072
  s_mov_b32 s58, 262144
  buffer_load_dwordx4 v13, s[20:23], s58 offen lds
  s_nop 9
  s_setprio 0
  v_exp_f32 v16, v16
  s_setprio 1
  v_exp_f32 v17, v17
  v_exp_f32 v18, v18
  v_exp_f32 v19, v19
  v_exp_f32 v20, v20
  v_exp_f32 v21, v21
  v_exp_f32 v22, v22
  v_exp_f32 v23, v23
  v_exp_f32 v24, v24
  v_exp_f32 v25, v25
  v_exp_f32 v26, v26
  v_exp_f32 v27, v27
  v_exp_f32 v28, v28
  v_exp_f32 v29, v29
  v_exp_f32 v30, v30
  v_exp_f32 v31, v31
  v_exp_f32 v32, v32
  v_exp_f32 v33, v33
  v_exp_f32 v34, v34
  v_exp_f32 v35, v35
  v_exp_f32 v36, v36
  v_exp_f32 v37, v37
  v_exp_f32 v38, v38
  v_exp_f32 v39, v39
  v_exp_f32 v40, v40
  v_exp_f32 v41, v41
  v_exp_f32 v42, v42
  v_exp_f32 v43, v43
  v_exp_f32 v44, v44
  v_exp_f32 v45, v45
  v_exp_f32 v46, v46
  v_exp_f32 v47, v47
  s_setprio 3
  s_waitcnt lgkmcnt(0)
  v_smfmac_f32_32x32x32_bf16 v[48:63], v[104:107], v[16:23], v5
  v_smfmac_f32_32x32x32_bf16 v[48:63], v[108:111], v[24:31], v5
  v_smfmac_f32_32x32x32_bf16 v[64:79], v[108:111], v[40:47], v5
  v_smfmac_f32_32x32x32_bf16 v[64:79], v[104:107], v[32:39], v5
  s_mov_b64 exec, s[52:53]
  ds_read_b128 v[96:99], v7 offset:0
  ds_read_b128 v[100:103], v7 offset:512
  s_mov_b64 exec, -1
  s_add_u32 m0, s57, 16384
  s_mov_b32 s58, 114688
  buffer_load_dwordx4 v14, s[44:47], s58 offen sc1 lds
  v_mfma_f32_32x32x16_bf16 v[16:31], v[88:91], v[80:83], 0
  ds_read_b128 v[92:95], v6 offset:4096
  s_add_u32 m0, s57, 81920
  s_mov_b32 s58, 393216
  buffer_load_dwordx4 v13, s[32:35], s58 offen lds
  v_mfma_f32_32x32x16_bf16 v[32:47], v[88:91], v[84:87], 0
  s_add_u32 m0, s57, 90112
  s_mov_b32 s58, 458752
  buffer_load_dwordx4 v13, s[32:35], s58 offen lds
  s_nop 9
  s_setprio 0
  v_exp_f32 v16, v16
  s_setprio 1
  v_exp_f32 v17, v17
  v_exp_f32 v18, v18
  v_exp_f32 v19, v19
  v_exp_f32 v20, v20
  v_exp_f32 v21, v21
  v_exp_f32 v22, v22
  v_exp_f32 v23, v23
  v_exp_f32 v24, v24
  v_exp_f32 v25, v25
  v_exp_f32 v26, v26
  v_exp_f32 v27, v27
  v_exp_f32 v28, v28
  v_exp_f32 v29, v29
  v_exp_f32 v30, v30
  v_exp_f32 v31, v31
  v_exp_f32 v32, v32
  v_exp_f32 v33, v33
  v_exp_f32 v34, v34
  v_exp_f32 v35, v35
  v_exp_f32 v36, v36
  v_exp_f32 v37, v37
  v_exp_f32 v38, v38
  v_exp_f32 v39, v39
  v_exp_f32 v40, v40
  v_exp_f32 v41, v41
  v_exp_f32 v42, v42
  v_exp_f32 v43, v43
  v_exp_f32 v44, v44
  v_exp_f32 v45, v45
  s_waitcnt vmcnt(7)
  v_exp_f32 v46, v46
  v_exp_f32 v47, v47
  s_setprio 3
  s_waitcnt lgkmcnt(0)
  v_smfmac_f32_32x32x32_bf16 v[48:63], v[96:99], v[16:23], v5
  s_barrier
  v_smfmac_f32_32x32x32_bf16 v[48:63], v[100:103], v[24:31], v5
  v_smfmac_f32_32x32x32_bf16 v[64:79], v[100:103], v[40:47], v5
  v_smfmac_f32_32x32x32_bf16 v[64:79], v[96:99], v[32:39], v5
  s_mov_b64 exec, s[52:53]
  ds_read_b128 v[104:107], v7 offset:4096
  ds_read_b128 v[108:111], v7 offset:4608
  s_mov_b64 exec, -1
  v_mfma_f32_32x32x16_bf16 v[16:31], v[92:95], v[80:83], 0
  ds_read_b128 v[88:91], v6 offset:8192
  s_add_u32 m0, s57, 49152
  s_mov_b32 s58, 131072
  buffer_load_dwordx4 v13, s[32:35], s58 offen lds
  v_mfma_f32_32x32x16_bf16 v[32:47], v[92:95], v[84:87], 0
  s_add_u32 m0, s57, 57344
  s_mov_b32 s58, 196608
  buffer_load_dwordx4 v13, s[32:35], s58 offen lds
  s_nop 9
  s_setprio 0
  v_exp_f32 v16, v16
  s_setprio 1
  v_exp_f32 v17, v17
  v_exp_f32 v18, v18
  v_exp_f32 v19, v19
  v_exp_f32 v20, v20
  v_exp_f32 v21, v21
  v_exp_f32 v22, v22
  v_exp_f32 v23, v23
  v_exp_f32 v24, v24
  v_exp_f32 v25, v25
  v_exp_f32 v26, v26
  v_exp_f32 v27, v27
  v_exp_f32 v28, v28
  v_exp_f32 v29, v29
  v_exp_f32 v30, v30
  v_exp_f32 v31, v31
  v_exp_f32 v32, v32
  v_exp_f32 v33, v33
  v_exp_f32 v34, v34
  v_exp_f32 v35, v35
  v_exp_f32 v36, v36
  v_exp_f32 v37, v37
  v_exp_f32 v38, v38
  v_exp_f32 v39, v39
  v_exp_f32 v40, v40
  v_exp_f32 v41, v41
  v_exp_f32 v42, v42
  v_exp_f32 v43, v43
  v_exp_f32 v44, v44
  v_exp_f32 v45, v45
  v_exp_f32 v46, v46
  v_exp_f32 v47, v47
  s_setprio 3
  s_waitcnt lgkmcnt(0)
  v_smfmac_f32_32x32x32_bf16 v[48:63], v[104:107], v[16:23], v5
  v_smfmac_f32_32x32x32_bf16 v[48:63], v[108:111], v[24:31], v5
  v_smfmac_f32_32x32x32_bf16 v[64:79], v[108:111], v[40:47], v5
  v_smfmac_f32_32x32x32_bf16 v[64:79], v[104:107], v[32:39], v5
  s_mov_b64 exec, s[52:53]
  ds_read_b128 v[96:99], v7 offset:8192
  ds_read_b128 v[100:103], v7 offset:8704
  s_mov_b64 exec, -1
  s_add_u32 m0, s57, 24576
  s_mov_b32 s58, 122880
  buffer_load_dwordx4 v14, s[44:47], s58 offen sc1 lds
  v_mfma_f32_32x32x16_bf16 v[16:31], v[88:91], v[80:83], 0
  ds_read_b128 v[92:95], v6 offset:12288
  s_add_u32 m0, s57, 65536
  s_mov_b32 s58, 262144
  buffer_load_dwordx4 v13, s[32:35], s58 offen lds
  v_mfma_f32_32x32x16_bf16 v[32:47], v[88:91], v[84:87], 0
  s_add_u32 m0, s57, 73728
  s_mov_b32 s58, 327680
  buffer_load_dwordx4 v13, s[32:35], s58 offen lds
  s_nop 9
  s_setprio 0
  v_exp_f32 v16, v16
  s_setprio 1
  v_exp_f32 v17, v17
  v_exp_f32 v18, v18
  v_exp_f32 v19, v19
  v_exp_f32 v20, v20
  v_exp_f32 v21, v21
  v_exp_f32 v22, v22
  v_exp_f32 v23, v23
  v_exp_f32 v24, v24
  v_exp_f32 v25, v25
  v_exp_f32 v26, v26
  v_exp_f32 v27, v27
  v_exp_f32 v28, v28
  v_exp_f32 v29, v29
  v_exp_f32 v30, v30
  v_exp_f32 v31, v31
  v_exp_f32 v32, v32
  v_exp_f32 v33, v33
  v_exp_f32 v34, v34
  v_exp_f32 v35, v35
  v_exp_f32 v36, v36
  v_exp_f32 v37, v37
  v_exp_f32 v38, v38
  v_exp_f32 v39, v39
  v_exp_f32 v40, v40
  v_exp_f32 v41, v41
  v_exp_f32 v42, v42
  v_exp_f32 v43, v43
  v_exp_f32 v44, v44
  v_exp_f32 v45, v45
  s_waitcnt vmcnt(7)
  v_exp_f32 v46, v46
  v_exp_f32 v47, v47
  s_setprio 3
  s_waitcnt lgkmcnt(0)
  v_smfmac_f32_32x32x32_bf16 v[48:63], v[96:99], v[16:23], v5
  s_barrier
  buffer_load_dwordx4 v[160:163], v2, s[44:47], s75 offen sc1
  v_smfmac_f32_32x32x32_bf16 v[48:63], v[100:103], v[24:31], v5
  buffer_load_dwordx4 v[164:167], v2, s[44:47], s75 offen offset:1024 sc1
  v_smfmac_f32_32x32x32_bf16 v[64:79], v[100:103], v[40:47], v5
  buffer_load_dwordx4 v[168:171], v2, s[44:47], s75 offen offset:2048 sc1
  v_smfmac_f32_32x32x32_bf16 v[64:79], v[96:99], v[32:39], v5
  s_mov_b64 exec, s[52:53]
  ds_read_b128 v[104:107], v7 offset:12288
  ds_read_b128 v[108:111], v7 offset:12800
L_padstart2:
L_pad2:
  s_cbranch_execz L_pad5
  s_mov_b64 exec, -1
  buffer_load_dwordx4 v[172:175], v2, s[44:47], s75 offen offset:3072 sc1
  v_mfma_f32_32x32x16_bf16 v[16:31], v[92:95], v[80:83], 0
  ds_read_b128 v[88:91], v6 offset:16384
  v_mfma_f32_32x32x16_bf16 v[32:47], v[92:95], v[84:87], 0
  s_nop 9
  s_setprio 0
  v_exp_f32 v16, v16
  s_setprio 1
  v_exp_f32 v17, v17
  v_exp_f32 v18, v18
  v_exp_f32 v19, v19
  v_exp_f32 v20, v20
  v_exp_f32 v21, v21
  v_exp_f32 v22, v22
  v_exp_f32 v23, v23
  v_exp_f32 v24, v24
  v_exp_f32 v25, v25
  v_exp_f32 v26, v26
  v_exp_f32 v27, v27
  v_exp_f32 v28, v28
  v_exp_f32 v29, v29
  v_exp_f32 v30, v30
  v_exp_f32 v31, v31
  v_exp_f32 v32, v32
  v_exp_f32 v33, v33
  v_exp_f32 v34, v34
  v_exp_f32 v35, v35
  v_exp_f32 v36, v36
  v_exp_f32 v37, v37
  v_exp_f32 v38, v38
  v_exp_f32 v39, v39
  v_exp_f32 v40, v40
  v_exp_f32 v41, v41
  v_exp_f32 v42, v42
  v_exp_f32 v43, v43
  v_exp_f32 v44, v44
  v_exp_f32 v45, v45
  v_exp_f32 v46, v46
  v_exp_f32 v47, v47
  s_setprio 2
  s_waitcnt vmcnt(0)
  v_max3_u32 v15, v160, v164, v168
  v_max_u32 v15, v15, v172
  v_cmp_eq_u32 vcc, -1, v15
  s_setprio 3
  s_waitcnt lgkmcnt(0)
  v_smfmac_f32_32x32x32_bf16 v[48:63], v[104:107], v[16:23], v5
  s_cbranch_vccnz L_slow_pm0_1
L_back_pm0_1:
  v_smfmac_f32_32x32x32_bf16 v[48:63], v[108:111], v[24:31], v5
  v_smfmac_f32_32x32x32_bf16 v[64:79], v[108:111], v[40:47], v5
  v_smfmac_f32_32x32x32_bf16 v[64:79], v[104:107], v[32:39], v5
  s_mov_b64 exec, s[52:53]
  ds_read_b128 v[96:99], v7 offset:16384
  ds_read_b128 v[100:103], v7 offset:16896
  s_mov_b64 exec, -1
  v_mfma_f32_32x32x16_bf16 v[16:31], v[88:91], v[80:83], 0
  ds_read_b128 v[92:95], v6 offset:20480
  v_mfma_f32_32x32x16_bf16 v[32:47], v[88:91], v[84:87], 0
  v_mfma_f32_32x32x16_bf16 v[112:127], v[160:163], v[136:139], 0
  v_mfma_f32_32x32x16_bf16 v[112:127], v[164:167], v[136:139], v[112:127]
  v_mfma_f32_32x32x16_bf16 v[112:127], v[168:171], v[136:139], v[112:127]
  v_mfma_f32_32x32x16_bf16 v[112:127], v[172:175], v[136:139], v[112:127]
  s_setprio 0
  v_exp_f32 v16, v16
  s_setprio 1
  v_exp_f32 v17, v17
  v_exp_f32 v18, v18
  v_exp_f32 v19, v19
  v_exp_f32 v20, v20
  v_exp_f32 v21, v21
  v_exp_f32 v22, v22
  v_exp_f32 v23, v23
  v_exp_f32 v24, v24
  v_exp_f32 v25, v25
  v_exp_f32 v26, v26
  v_exp_f32 v27, v27
  v_add_f32 v120, 0x358637bd, v120
  v_rcp_f32 v120, v120
  s_nop 0
  v_mul_f32 v112, v112, v120
  v_mul_f32 v113, v113, v120
  v_mul_f32 v114, v114, v120
  v_mul_f32 v115, v115, v120
  v_mul_f32 v116, v116, v120
  v_mul_f32 v117, v117, v120
  v_mul_f32 v118, v118, v120
  v_mul_f32 v119, v119, v120
  v_cvt_pk_bf16_f32 v252, v112, v113
  v_cvt_pk_bf16_f32 v253, v114, v115
  v_cvt_pk_bf16_f32 v254, v116, v117
  v_cvt_pk_bf16_f32 v255, v118, v119
  v_min_u32 v252, -2, v252
  s_mov_b32 s58, 3145728
  s_cmp_lg_u32 s72, 0
  s_cbranch_scc1 L_far_ob0
  buffer_store_dwordx4 v[252:255], v236, s[44:47], s58 offen
L_near_ob0:
  v_exp_f32 v28, v28
  v_exp_f32 v29, v29
  v_exp_f32 v30, v30
  v_exp_f32 v31, v31
  v_exp_f32 v32, v32
  v_exp_f32 v33, v33
  v_exp_f32 v34, v34
  v_exp_f32 v35, v35
  v_exp_f32 v36, v36
  v_exp_f32 v37, v37
  v_exp_f32 v38, v38
  v_exp_f32 v39, v39
  v_exp_f32 v40, v40
  v_exp_f32 v41, v41
  v_exp_f32 v42, v42
  v_exp_f32 v43, v43
  v_exp_f32 v44, v44
  v_exp_f32 v45, v45
  v_exp_f32 v46, v46
  v_exp_f32 v47, v47
  s_setprio 3
  s_waitcnt lgkmcnt(0)
  v_smfmac_f32_32x32x32_bf16 v[48:63], v[96:99], v[16:23], v5
  s_barrier
  ds_read_b64_tr_b16 v[112:113], v232 offset:0
  ds_read_b64_tr_b16 v[114:115], v232 offset:1024
  ds_read_b64_tr_b16 v[116:117], v233 offset:0
  v_smfmac_f32_32x32x32_bf16 v[48:63], v[100:103], v[24:31], v5
  ds_read_b64_tr_b16 v[118:119], v233 offset:1024
  ds_read_b64_tr_b16 v[120:121], v234 offset:0
  ds_read_b64_tr_b16 v[122:123], v234 offset:1024
  v_smfmac_f32_32x32x32_bf16 v[64:79], v[100:103], v[40:47], v5
  ds_read_b64_tr_b16 v[124:125], v235 offset:0
  ds_read_b64_tr_b16 v[126:127], v235 offset:1024
  ds_read_b64_tr_b16 v[128:129], v232 offset:4096
  v_smfmac_f32_32x32x32_bf16 v[64:79], v[96:99], v[32:39], v5
  s_mov_b64 exec, s[52:53]
  ds_read_b128 v[104:107], v7 offset:20480
  ds_read_b128 v[108:111], v7 offset:20992
  s_mov_b64 exec, -1
  ds_read_b64_tr_b16 v[130:131], v232 offset:5120
  ds_read_b64_tr_b16 v[132:133], v233 offset:4096
  ds_read_b64_tr_b16 v[134:135], v233 offset:5120
  v_mfma_f32_32x32x16_bf16 v[16:31], v[92:95], v[80:83], 0
  ds_read_b128 v[88:91], v6 offset:24576
  s_waitcnt lgkmcnt(11)
  ds_read_b64_tr_b16 v[136:137], v234 offset:4096
  ds_read_b64_tr_b16 v[138:139], v234 offset:5120
  ds_read_b64_tr_b16 v[140:141], v235 offset:4096
  v_mfma_f32_32x32x16_bf16 v[32:47], v[92:95], v[84:87], 0
  ds_read_b64_tr_b16 v[142:143], v235 offset:5120
  s_nop 9
  s_setprio 0
  v_exp_f32 v16, v16
  s_setprio 1
  v_exp_f32 v17, v17
  v_exp_f32 v18, v18
  v_exp_f32 v19, v19
  v_exp_f32 v20, v20
  v_exp_f32 v21, v21
  v_exp_f32 v22, v22
  v_exp_f32 v23, v23
  v_exp_f32 v24, v24
  v_exp_f32 v25, v25
  v_exp_f32 v26, v26
  v_exp_f32 v27, v27
  v_exp_f32 v28, v28
  v_exp_f32 v29, v29
  v_exp_f32 v30, v30
  v_exp_f32 v31, v31
  v_exp_f32 v32, v32
  v_exp_f32 v33, v33
  v_exp_f32 v34, v34
  v_exp_f32 v35, v35
  v_exp_f32 v36, v36
  v_exp_f32 v37, v37
  v_exp_f32 v38, v38
  v_exp_f32 v39, v39
  v_exp_f32 v40, v40
  v_exp_f32 v41, v41
  v_exp_f32 v42, v42
  v_exp_f32 v43, v43
  v_exp_f32 v44, v44
  v_exp_f32 v45, v45
  v_exp_f32 v46, v46
  v_exp_f32 v47, v47
  s_setprio 3
  s_waitcnt lgkmcnt(0)
  v_smfmac_f32_32x32x32_bf16 v[48:63], v[104:107], v[16:23], v5
  buffer_load_dwordx4 v[144:147], v2, s[44:47], s77 offen sc1
  buffer_load_dwordx4 v[148:151], v2, s[44:47], s77 offen offset:1024 sc1
  v_smfmac_f32_32x32x32_bf16 v[48:63], v[108:111], v[24:31], v5
  buffer_load_dwordx4 v[152:155], v2, s[44:47], s77 offen offset:2048 sc1
  v_smfmac_f32_32x32x32_bf16 v[64:79], v[108:111], v[40:47], v5
  buffer_load_dwordx4 v[156:159], v2, s[44:47], s77 offen offset:3072 sc1
  v_smfmac_f32_32x32x32_bf16 v[64:79], v[104:107], v[32:39], v5
  s_mov_b64 exec, s[52:53]
  ds_read_b128 v[96:99], v7 offset:24576
  ds_read_b128 v[100:103], v7 offset:25088
  s_mov_b64 exec, -1
  buffer_load_dwordx4 v[160:163], v2, s[44:47], s8 offen sc1
  buffer_load_dwordx4 v[164:167], v2, s[44:47], s8 offen offset:1024 sc1
  v_mfma_f32_32x32x16_bf16 v[16:31], v[88:91], v[80:83], 0
  ds_read_b128 v[92:95], v6 offset:28672
  buffer_load_dwordx4 v[168:171], v2, s[44:47], s8 offen offset:2048 sc1
  v_mfma_f32_32x32x16_bf16 v[32:47], v[88:91], v[84:87], 0
  buffer_load_dwordx4 v[172:175], v2, s[44:47], s8 offen offset:3072 sc1
  s_nop 9
  s_setprio 0
  v_exp_f32 v16, v16
  s_setprio 1
  v_exp_f32 v17, v17
  v_exp_f32 v18, v18
  v_exp_f32 v19, v19
  v_exp_f32 v20, v20
  v_exp_f32 v21, v21
  v_exp_f32 v22, v22
  v_exp_f32 v23, v23
  v_exp_f32 v24, v24
  v_exp_f32 v25, v25
  v_exp_f32 v26, v26
  v_exp_f32 v27, v27
  v_exp_f32 v28, v28
  v_exp_f32 v29, v29
  v_exp_f32 v30, v30
  v_exp_f32 v31, v31
  v_exp_f32 v32, v32
  v_exp_f32 v33, v33
  v_exp_f32 v34, v34
  v_exp_f32 v35, v35
  v_exp_f32 v36, v36
  v_exp_f32 v37, v37
  v_exp_f32 v38, v38
  v_exp_f32 v39, v39
  v_exp_f32 v40, v40
  v_exp_f32 v41, v41
  v_exp_f32 v42, v42
  v_exp_f32 v43, v43
  v_exp_f32 v44, v44
  v_exp_f32 v45, v45
  v_exp_f32 v46, v46
  v_exp_f32 v47, v47
  s_setprio 3
  s_waitcnt lgkmcnt(0)
  v_smfmac_f32_32x32x32_bf16 v[48:63], v[96:99], v[16:23], v5
  s_barrier
  buffer_load_dwordx4 v[176:179], v2, s[44:47], s9 offen sc1
  buffer_load_dwordx4 v[180:183], v2, s[44:47], s9 offen offset:1024 sc1
  v_smfmac_f32_32x32x32_bf16 v[48:63], v[100:103], v[24:31], v5
  buffer_load_dwordx4 v[184:187], v2, s[44:47], s9 offen offset:2048 sc1
  v_smfmac_f32_32x32x32_bf16 v[64:79], v[100:103], v[40:47], v5
  buffer_load_dwordx4 v[188:191], v2, s[44:47], s9 offen offset:3072 sc1
  v_smfmac_f32_32x32x32_bf16 v[64:79], v[96:99], v[32:39], v5
  s_mov_b64 exec, s[52:53]
  ds_read_b128 v[104:107], v7 offset:28672
  ds_read_b128 v[108:111], v7 offset:29184
  s_mov_b64 exec, -1
  buffer_load_dwordx4 v[192:195], v2, s[44:47], s10 offen sc1
  buffer_load_dwordx4 v[196:199], v2, s[44:47], s10 offen offset:1024 sc1
  v_mfma_f32_32x32x16_bf16 v[16:31], v[92:95], v[80:83], 0
  buffer_load_dwordx4 v[200:203], v2, s[44:47], s10 offen offset:2048 sc1
  v_mfma_f32_32x32x16_bf16 v[32:47], v[92:95], v[84:87], 0
  buffer_load_dwordx4 v[204:207], v2, s[44:47], s10 offen offset:3072 sc1
  s_and_b32 s58, s2, -8
  s_add_u32 s58, s58, s3
  s_cmp_eq_u32 s58, 8
  s_cbranch_scc1 L_wb_P30
L_wbb_P30:
  s_nop 9
  s_setprio 0
  v_exp_f32 v16, v16
  s_setprio 1
  v_exp_f32 v17, v17
  v_exp_f32 v18, v18
  v_exp_f32 v19, v19
  v_exp_f32 v20, v20
  v_exp_f32 v21, v21
  v_exp_f32 v22, v22
  v_exp_f32 v23, v23
  v_exp_f32 v24, v24
  v_exp_f32 v25, v25
  v_exp_f32 v26, v26
  v_exp_f32 v27, v27
  v_exp_f32 v28, v28
  v_exp_f32 v29, v29
  v_exp_f32 v30, v30
  v_exp_f32 v31, v31
  v_exp_f32 v32, v32
  v_exp_f32 v33, v33
  v_exp_f32 v34, v34
  v_exp_f32 v35, v35
  v_exp_f32 v36, v36
  v_exp_f32 v37, v37
  v_exp_f32 v38, v38
  v_exp_f32 v39, v39
  v_exp_f32 v40, v40
  v_exp_f32 v41, v41
  v_exp_f32 v42, v42
  v_exp_f32 v43, v43
  v_exp_f32 v44, v44
  v_exp_f32 v45, v45
  v_exp_f32 v46, v46
  v_exp_f32 v47, v47
  s_setprio 3
  s_waitcnt lgkmcnt(0)
  v_smfmac_f32_32x32x32_bf16 v[48:63], v[104:107], v[16:23], v5
  v_smfmac_f32_32x32x32_bf16 v[48:63], v[108:111], v[24:31], v5
  v_smfmac_f32_32x32x32_bf16 v[64:79], v[104:107], v[32:39], v5
  v_smfmac_f32_32x32x32_bf16 v[64:79], v[108:111], v[40:47], v5
  s_nop 7
  s_nop 3
  ds_write_b128 v242, v[64:67] offset:0
  ds_write_b128 v242, v[68:71] offset:1024
  ds_write_b32 v242, v72 offset:2048
  s_waitcnt lgkmcnt(0)
  s_barrier
  ds_read_b32 v24, v243 offset:2048
  ds_read_b128 v[16:19], v243 offset:0
  ds_read_b128 v[20:23], v243 offset:1024
  s_waitcnt lgkmcnt(2)
  v_add_f32 v56, v56, v24
  v_rcp_f32 v58, v56
  s_waitcnt lgkmcnt(1)
  v_pk_add_f32 v[48:49], v[48:49], v[16:17]
  v_pk_add_f32 v[50:51], v[50:51], v[18:19]
  s_waitcnt lgkmcnt(0)
  v_pk_add_f32 v[52:53], v[52:53], v[20:21]
  v_pk_add_f32 v[54:55], v[54:55], v[22:23]
  v_pk_add_f32 v[26:27], v[48:49], v[50:51]
  v_pk_mul_f32 v[16:17], v[48:49], v[58:59] op_sel_hi:[1,0]
  v_pk_add_f32 v[28:29], v[52:53], v[54:55]
  v_pk_mul_f32 v[18:19], v[50:51], v[58:59] op_sel_hi:[1,0]
  v_pk_add_f32 v[26:27], v[26:27], v[28:29]
  v_pk_mul_f32 v[20:21], v[52:53], v[58:59] op_sel_hi:[1,0]
  v_add_f32 v26, v26, v27
  v_pk_mul_f32 v[22:23], v[54:55], v[58:59] op_sel_hi:[1,0]
  v_fma_f32 v26, v26, 0, v56
  v_cvt_pk_bf16_f32 v252, v16, v17
  v_subrev_u32 v26, 729808896, v26
  v_cvt_pk_bf16_f32 v253, v18, v19
  v_cmp_lt_u32 vcc, 1006632960, v26
  v_cvt_pk_bf16_f32 v254, v20, v21
  v_cvt_pk_bf16_f32 v255, v22, v23
  v_min_u32 v252, -2, v252
  s_cbranch_vccnz L_fb0
L_fbback0:
  s_mov_b32 s58, 1048576
  s_cmp_lg_u32 s72, 0
  s_cbranch_scc1 L_far_oa0
  buffer_store_dwordx4 v[252:255], v236, s[44:47], s58 offen
L_near_oa0:
  s_setprio 0
  s_waitcnt vmcnt(13)
  v_max3_u32 v15, v144, v148, v152
  v_max_u32 v15, v15, v156
  v_cmp_eq_u32 vcc, -1, v15
  s_nop 0
  s_cbranch_vccnz L_slow_f0_0
L_back_f0_0:
  v_mfma_f32_16x16x32_bf16 v[208:211], v[112:115], v[144:147], 0
  ds_read_b64_tr_b16 v[32:33], v232 offset:8192
  ds_read_b64_tr_b16 v[34:35], v232 offset:9216
  v_mfma_f32_16x16x32_bf16 v[212:215], v[116:119], v[144:147], 0
  ds_read_b64_tr_b16 v[36:37], v233 offset:8192
  ds_read_b64_tr_b16 v[38:39], v233 offset:9216
  v_mfma_f32_16x16x32_bf16 v[216:219], v[120:123], v[144:147], 0
  ds_read_b64_tr_b16 v[40:41], v234 offset:8192
  ds_read_b64_tr_b16 v[42:43], v234 offset:9216
  v_mfma_f32_16x16x32_bf16 v[220:223], v[124:127], v[144:147], 0
  ds_read_b64_tr_b16 v[44:45], v235 offset:8192
  ds_read_b64_tr_b16 v[46:47], v235 offset:9216
  s_waitcnt lgkmcnt(7)
  v_mfma_f32_16x16x32_bf16 v[208:211], v[128:131], v[148:151], v[208:211]
  ds_read_b64_tr_b16 v[64:65], v232 offset:12288
  ds_read_b64_tr_b16 v[66:67], v232 offset:13312
  v_mfma_f32_16x16x32_bf16 v[212:215], v[132:135], v[148:151], v[212:215]
  ds_read_b64_tr_b16 v[68:69], v233 offset:12288
  ds_read_b64_tr_b16 v[70:71], v233 offset:13312
  v_mfma_f32_16x16x32_bf16 v[216:219], v[136:139], v[148:151], v[216:219]
  ds_read_b64_tr_b16 v[72:73], v234 offset:12288
  ds_read_b64_tr_b16 v[74:75], v234 offset:13312
  v_mfma_f32_16x16x32_bf16 v[220:223], v[140:143], v[148:151], v[220:223]
  ds_read_b64_tr_b16 v[76:77], v235 offset:12288
  ds_read_b64_tr_b16 v[78:79], v235 offset:13312
  s_waitcnt lgkmcnt(7)
  v_mfma_f32_16x16x32_bf16 v[208:211], v[32:35], v[152:155], v[208:211]
  ds_read_b64_tr_b16 v[16:17], v232 offset:16384
  ds_read_b64_tr_b16 v[18:19], v232 offset:17408
  v_mfma_f32_16x16x32_bf16 v[212:215], v[36:39], v[152:155], v[212:215]
  ds_read_b64_tr_b16 v[20:21], v233 offset:16384
  ds_read_b64_tr_b16 v[22:23], v233 offset:17408
  v_mfma_f32_16x16x32_bf16 v[216:219], v[40:43], v[152:155], v[216:219]
  ds_read_b64_tr_b16 v[24:25], v234 offset:16384
  ds_read_b64_tr_b16 v[26:27], v234 offset:17408
  v_mfma_f32_16x16x32_bf16 v[220:223], v[44:47], v[152:155], v[220:223]
  ds_read_b64_tr_b16 v[28:29], v235 offset:16384
  ds_read_b64_tr_b16 v[30:31], v235 offset:17408
  s_waitcnt lgkmcnt(7)
  v_mfma_f32_16x16x32_bf16 v[208:211], v[64:67], v[156:159], v[208:211]
  ds_read_b64_tr_b16 v[48:49], v232 offset:20480
  ds_read_b64_tr_b16 v[50:51], v232 offset:21504
  v_mfma_f32_16x16x32_bf16 v[212:215], v[68:71], v[156:159], v[212:215]
  ds_read_b64_tr_b16 v[52:53], v233 offset:20480
  ds_read_b64_tr_b16 v[54:55], v233 offset:21504
  v_mfma_f32_16x16x32_bf16 v[216:219], v[72:75], v[156:159], v[216:219]
  ds_read_b64_tr_b16 v[56:57], v234 offset:20480
  ds_read_b64_tr_b16 v[58:59], v234 offset:21504
  v_mfma_f32_16x16x32_bf16 v[220:223], v[76:79], v[156:159], v[220:223]
  ds_read_b64_tr_b16 v[60:61], v235 offset:20480
  ds_read_b64_tr_b16 v[62:63], v235 offset:21504
  s_waitcnt lgkmcnt(7)
  s_waitcnt vmcnt(9)
  v_max3_u32 v15, v160, v164, v168
  v_max_u32 v15, v15, v172
  v_cmp_eq_u32 vcc, -1, v15
  s_nop 0
  s_cbranch_vccnz L_slow_f0_1
L_back_f0_1:
  s_and_b32 s58, s2, -8
  s_add_u32 s58, s58, s3
  s_cmp_eq_u32 s58, 16
  s_cbranch_scc1 L_wb_B1
L_wbb_B1:
  v_mfma_f32_16x16x32_bf16 v[208:211], v[16:19], v[160:163], v[208:211]
  ds_read_b64_tr_b16 v[80:81], v232 offset:24576
  ds_read_b64_tr_b16 v[82:83], v232 offset:25600
  v_mfma_f32_16x16x32_bf16 v[212:215], v[20:23], v[160:163], v[212:215]
  ds_read_b64_tr_b16 v[84:85], v233 offset:24576
  ds_read_b64_tr_b16 v[86:87], v233 offset:25600
  v_mfma_f32_16x16x32_bf16 v[216:219], v[24:27], v[160:163], v[216:219]
  ds_read_b64_tr_b16 v[88:89], v234 offset:24576
  ds_read_b64_tr_b16 v[90:91], v234 offset:25600
  v_mfma_f32_16x16x32_bf16 v[220:223], v[28:31], v[160:163], v[220:223]
  ds_read_b64_tr_b16 v[92:93], v235 offset:24576
  ds_read_b64_tr_b16 v[94:95], v235 offset:25600
  s_waitcnt lgkmcnt(7)
  v_mfma_f32_16x16x32_bf16 v[208:211], v[48:51], v[164:167], v[208:211]
  ds_read_b64_tr_b16 v[96:97], v232 offset:28672
  ds_read_b64_tr_b16 v[98:99], v232 offset:29696
  v_mfma_f32_16x16x32_bf16 v[212:215], v[52:55], v[164:167], v[212:215]
  ds_read_b64_tr_b16 v[100:101], v233 offset:28672
  ds_read_b64_tr_b16 v[102:103], v233 offset:29696
  v_mfma_f32_16x16x32_bf16 v[216:219], v[56:59], v[164:167], v[216:219]
  ds_read_b64_tr_b16 v[104:105], v234 offset:28672
  ds_read_b64_tr_b16 v[106:107], v234 offset:29696
  v_mfma_f32_16x16x32_bf16 v[220:223], v[60:63], v[164:167], v[220:223]
  ds_read_b64_tr_b16 v[108:109], v235 offset:28672
  ds_read_b64_tr_b16 v[110:111], v235 offset:29696
  s_waitcnt lgkmcnt(7)
  v_mfma_f32_16x16x32_bf16 v[208:211], v[80:83], v[168:171], v[208:211]
  ds_read_b64_tr_b16 v[112:113], v232 offset:32768
  ds_read_b64_tr_b16 v[114:115], v232 offset:33792
  v_mfma_f32_16x16x32_bf16 v[212:215], v[84:87], v[168:171], v[212:215]
  ds_read_b64_tr_b16 v[116:117], v233 offset:32768
  ds_read_b64_tr_b16 v[118:119], v233 offset:33792
  v_mfma_f32_16x16x32_bf16 v[216:219], v[88:91], v[168:171], v[216:219]
  ds_read_b64_tr_b16 v[120:121], v234 offset:32768
  ds_read_b64_tr_b16 v[122:123], v234 offset:33792
  v_mfma_f32_16x16x32_bf16 v[220:223], v[92:95], v[168:171], v[220:223]
  ds_read_b64_tr_b16 v[124:125], v235 offset:32768
  ds_read_b64_tr_b16 v[126:127], v235 offset:33792
  s_waitcnt lgkmcnt(7)
  v_mfma_f32_16x16x32_bf16 v[208:211], v[96:99], v[172:175], v[208:211]
  ds_read_b64_tr_b16 v[128:129], v232 offset:36864
  ds_read_b64_tr_b16 v[130:131], v232 offset:37888
  v_mfma_f32_16x16x32_bf16 v[212:215], v[100:103], v[172:175], v[212:215]
  ds_read_b64_tr_b16 v[132:133], v233 offset:36864
  ds_read_b64_tr_b16 v[134:135], v233 offset:37888
  v_mfma_f32_16x16x32_bf16 v[216:219], v[104:107], v[172:175], v[216:219]
  ds_read_b64_tr_b16 v[136:137], v234 offset:36864
  ds_read_b64_tr_b16 v[138:139], v234 offset:37888
  v_mfma_f32_16x16x32_bf16 v[220:223], v[108:111], v[172:175], v[220:223]
  ds_read_b64_tr_b16 v[140:141], v235 offset:36864
  ds_read_b64_tr_b16 v[142:143], v235 offset:37888
  s_waitcnt lgkmcnt(7)
  s_waitcnt vmcnt(5)
  v_max3_u32 v15, v176, v180, v184
  v_max_u32 v15, v15, v188
  v_cmp_eq_u32 vcc, -1, v15
  s_nop 0
  s_cbranch_vccnz L_slow_f0_2
L_back_f0_2:
  v_mfma_f32_16x16x32_bf16 v[208:211], v[112:115], v[176:179], v[208:211]
  ds_read_b64_tr_b16 v[32:33], v232 offset:40960
  ds_read_b64_tr_b16 v[34:35], v232 offset:41984
  v_mfma_f32_16x16x32_bf16 v[212:215], v[116:119], v[176:179], v[212:215]
  ds_read_b64_tr_b16 v[36:37], v233 offset:40960
  ds_read_b64_tr_b16 v[38:39], v233 offset:41984
  v_mfma_f32_16x16x32_bf16 v[216:219], v[120:123], v[176:179], v[216:219]
  ds_read_b64_tr_b16 v[40:41], v234 offset:40960
  ds_read_b64_tr_b16 v[42:43], v234 offset:41984
  v_mfma_f32_16x16x32_bf16 v[220:223], v[124:127], v[176:179], v[220:223]
  ds_read_b64_tr_b16 v[44:45], v235 offset:40960
  ds_read_b64_tr_b16 v[46:47], v235 offset:41984
  s_waitcnt lgkmcnt(7)
  v_mfma_f32_16x16x32_bf16 v[208:211], v[128:131], v[180:183], v[208:211]
  ds_read_b64_tr_b16 v[64:65], v232 offset:45056
  ds_read_b64_tr_b16 v[66:67], v232 offset:46080
  v_mfma_f32_16x16x32_bf16 v[212:215], v[132:135], v[180:183], v[212:215]
  ds_read_b64_tr_b16 v[68:69], v233 offset:45056
  ds_read_b64_tr_b16 v[70:71], v233 offset:46080
  v_mfma_f32_16x16x32_bf16 v[216:219], v[136:139], v[180:183], v[216:219]
  ds_read_b64_tr_b16 v[72:73], v234 offset:45056
  ds_read_b64_tr_b16 v[74:75], v234 offset:46080
  v_mfma_f32_16x16x32_bf16 v[220:223], v[140:143], v[180:183], v[220:223]
  ds_read_b64_tr_b16 v[76:77], v235 offset:45056
  ds_read_b64_tr_b16 v[78:79], v235 offset:46080
  s_waitcnt lgkmcnt(7)
  v_mfma_f32_16x16x32_bf16 v[208:211], v[32:35], v[184:187], v[208:211]
  ds_read_b64_tr_b16 v[16:17], v232 offset:49152
  ds_read_b64_tr_b16 v[18:19], v232 offset:50176
  v_mfma_f32_16x16x32_bf16 v[212:215], v[36:39], v[184:187], v[212:215]
  ds_read_b64_tr_b16 v[20:21], v233 offset:49152
  ds_read_b64_tr_b16 v[22:23], v233 offset:50176
  v_mfma_f32_16x16x32_bf16 v[216:219], v[40:43], v[184:187], v[216:219]
  ds_read_b64_tr_b16 v[24:25], v234 offset:49152
  ds_read_b64_tr_b16 v[26:27], v234 offset:50176
  v_mfma_f32_16x16x32_bf16 v[220:223], v[44:47], v[184:187], v[220:223]
  ds_read_b64_tr_b16 v[28:29], v235 offset:49152
  ds_read_b64_tr_b16 v[30:31], v235 offset:50176
  s_waitcnt lgkmcnt(7)
  v_mfma_f32_16x16x32_bf16 v[208:211], v[64:67], v[188:191], v[208:211]
  ds_read_b64_tr_b16 v[48:49], v232 offset:53248
  ds_read_b64_tr_b16 v[50:51], v232 offset:54272
  v_mfma_f32_16x16x32_bf16 v[212:215], v[68:71], v[188:191], v[212:215]
  ds_read_b64_tr_b16 v[52:53], v233 offset:53248
  ds_read_b64_tr_b16 v[54:55], v233 offset:54272
  v_mfma_f32_16x16x32_bf16 v[216:219], v[72:75], v[188:191], v[216:219]
  ds_read_b64_tr_b16 v[56:57], v234 offset:53248
  ds_read_b64_tr_b16 v[58:59], v234 offset:54272
  v_mfma_f32_16x16x32_bf16 v[220:223], v[76:79], v[188:191], v[220:223]
  ds_read_b64_tr_b16 v[60:61], v235 offset:53248
  ds_read_b64_tr_b16 v[62:63], v235 offset:54272
  s_waitcnt lgkmcnt(7)
  s_waitcnt vmcnt(1)
  v_max3_u32 v15, v192, v196, v200
  v_max_u32 v15, v15, v204
  v_cmp_eq_u32 vcc, -1, v15
  s_nop 0
  s_cbranch_vccnz L_slow_f0_3
L_back_f0_3:
  v_mfma_f32_16x16x32_bf16 v[208:211], v[16:19], v[192:195], v[208:211]
  ds_read_b64_tr_b16 v[80:81], v232 offset:57344
  ds_read_b64_tr_b16 v[82:83], v232 offset:58368
  v_mfma_f32_16x16x32_bf16 v[212:215], v[20:23], v[192:195], v[212:215]
  ds_read_b64_tr_b16 v[84:85], v233 offset:57344
  ds_read_b64_tr_b16 v[86:87], v233 offset:58368
  v_mfma_f32_16x16x32_bf16 v[216:219], v[24:27], v[192:195], v[216:219]
  ds_read_b64_tr_b16 v[88:89], v234 offset:57344
  ds_read_b64_tr_b16 v[90:91], v234 offset:58368
  v_mfma_f32_16x16x32_bf16 v[220:223], v[28:31], v[192:195], v[220:223]
  ds_read_b64_tr_b16 v[92:93], v235 offset:57344
  ds_read_b64_tr_b16 v[94:95], v235 offset:58368
  s_waitcnt lgkmcnt(7)
  v_mfma_f32_16x16x32_bf16 v[208:211], v[48:51], v[196:199], v[208:211]
  ds_read_b64_tr_b16 v[96:97], v232 offset:61440
  ds_read_b64_tr_b16 v[98:99], v232 offset:62464
  v_mfma_f32_16x16x32_bf16 v[212:215], v[52:55], v[196:199], v[212:215]
  ds_read_b64_tr_b16 v[100:101], v233 offset:61440
  ds_read_b64_tr_b16 v[102:103], v233 offset:62464
  v_mfma_f32_16x16x32_bf16 v[216:219], v[56:59], v[196:199], v[216:219]
  ds_read_b64_tr_b16 v[104:105], v234 offset:61440
  ds_read_b64_tr_b16 v[106:107], v234 offset:62464
  v_mfma_f32_16x16x32_bf16 v[220:223], v[60:63], v[196:199], v[220:223]
  ds_read_b64_tr_b16 v[108:109], v235 offset:61440
  ds_read_b64_tr_b16 v[110:111], v235 offset:62464
  s_waitcnt lgkmcnt(7)
  v_mfma_f32_16x16x32_bf16 v[208:211], v[80:83], v[200:203], v[208:211]
  v_mfma_f32_16x16x32_bf16 v[212:215], v[84:87], v[200:203], v[212:215]
  v_mfma_f32_16x16x32_bf16 v[216:219], v[88:91], v[200:203], v[216:219]
  v_mfma_f32_16x16x32_bf16 v[220:223], v[92:95], v[200:203], v[220:223]
  s_waitcnt lgkmcnt(0)
  v_mfma_f32_16x16x32_bf16 v[208:211], v[96:99], v[204:207], v[208:211]
  v_mfma_f32_16x16x32_bf16 v[212:215], v[100:103], v[204:207], v[212:215]
  v_mfma_f32_16x16x32_bf16 v[216:219], v[104:107], v[204:207], v[216:219]
  v_mfma_f32_16x16x32_bf16 v[220:223], v[108:111], v[204:207], v[220:223]
  s_nop 4
  v_cvt_pk_bf16_f32 v16, v208, v209
  v_cvt_pk_bf16_f32 v17, v210, v211
  v_cvt_pk_bf16_f32 v18, v212, v213
  v_cvt_pk_bf16_f32 v19, v214, v215
  v_cvt_pk_bf16_f32 v20, v216, v217
  v_cvt_pk_bf16_f32 v21, v218, v219
  v_cvt_pk_bf16_f32 v22, v220, v221
  v_cvt_pk_bf16_f32 v23, v222, v223
  s_nop 1
  v_permlane16_swap_b32 v16, v18
  v_permlane16_swap_b32 v17, v19
  v_permlane16_swap_b32 v20, v22
  v_permlane16_swap_b32 v21, v23
  buffer_store_dwordx4 v[16:19], v237, s[36:39], 0 offen nt
  buffer_store_dwordx4 v[20:23], v237, s[36:39], 0 offen offset:64 nt
  s_endpgm
L_side:
L_spin_p1a:
  s_mov_b32 s76, 0
L_spinl_p1a:
  buffer_load_dword v247, v210, s[44:47], 0 offen sc1
  s_add_u32 s76, s76, 1
  s_waitcnt vmcnt(0)
  v_xor_b32 v247, v247, v4
  v_cmp_lt_u32 vcc, 15, v247
  s_cmp_gt_u32 s76, 0x100000
  s_cbranch_scc1 L_back_p1a
  s_cbranch_vccnz L_spinl_p1a
  s_branch L_back_p1a
L_slow_kv0:
  s_mov_b32 s76, 0
L_slowl_kv0:
  s_add_u32 m0, s48, 0
  s_add_u32 s67, s48, 0
  buffer_load_dwordx4 v2, s[44:47], s67 offen sc1 lds
  buffer_load_dwordx4 v2, s[44:47], s67 offen offset:1024 sc1 lds
  s_add_u32 s76, s76, 1
  s_waitcnt vmcnt(0)
  ds_read_b128 v[112:115], v210 offset:0
  ds_read_b128 v[116:119], v210 offset:1024
  s_waitcnt lgkmcnt(0)
  v_max3_u32 v15, v112, v114, v116
  v_max3_u32 v15, v15, v118, v118
  v_cmp_eq_u32 vcc, -1, v15
  s_cmp_gt_u32 s76, 0x100000
  s_cbranch_vccz L_back_kv0
  s_cbranch_scc1 L_back_kv0
  s_branch L_slowl_kv0
L_spin_p1b:
  s_mov_b32 s76, 0
L_spinl_p1b:
  buffer_load_dword v247, v244, s[44:47], s54 offen sc1
  s_add_u32 s76, s76, 1
  s_waitcnt vmcnt(0)
  v_xor_b32 v247, v247, v4
  v_cmp_lt_u32 vcc, 15, v247
  s_cmp_gt_u32 s76, 0x100000
  s_cbranch_scc1 L_back_p1b
  s_cbranch_vccnz L_spinl_p1b
  s_branch L_back_p1b
L_far_ca0:
  buffer_store_dwordx4 v[136:139], v236, s[44:47], s58 offen sc1
  s_branch L_near_ca0
L_far_cb0:
  buffer_store_dwordx4 v[136:139], v236, s[44:47], s58 offen sc1
  s_branch L_near_cb0
L_wb_P19:
  buffer_wbl2 sc1
  s_branch L_wbb_P19
L_spin_pc:
  s_mov_b32 s76, 0
L_spinl_pc:
  buffer_load_dword v247, v140, s[44:47], 0 offen sc1
  s_add_u32 s76, s76, 1
  s_waitcnt vmcnt(0)
  v_xor_b32 v247, v247, v4
  v_cmp_lt_u32 vcc, 15, v247
  s_cmp_gt_u32 s76, 0x100000
  s_cbranch_scc1 L_back_pc
  s_cbranch_vccnz L_spinl_pc
  s_branch L_back_pc
L_slow_pm0_1:
  s_mov_b32 s76, 0
L_slowl_pm0_1:
  buffer_load_dwordx4 v[160:163], v2, s[44:47], s75 offen sc1
  buffer_load_dwordx4 v[164:167], v2, s[44:47], s75 offen offset:1024 sc1
  buffer_load_dwordx4 v[168:171], v2, s[44:47], s75 offen offset:2048 sc1
  buffer_load_dwordx4 v[172:175], v2, s[44:47], s75 offen offset:3072 sc1
  s_add_u32 s76, s76, 1
  s_waitcnt vmcnt(0)
  v_max3_u32 v15, v160, v164, v168
  v_max_u32 v15, v15, v172
  v_cmp_eq_u32 vcc, -1, v15
  s_cmp_gt_u32 s76, 0x100000
  s_cbranch_vccz L_back_pm0_1
  s_cbranch_scc1 L_back_pm0_1
  s_branch L_slowl_pm0_1
L_far_ob0:
  buffer_store_dwordx4 v[252:255], v236, s[44:47], s58 offen sc1
  s_branch L_near_ob0
L_wb_P30:
  buffer_wbl2 sc1
  s_branch L_wbb_P30
L_fb0:
  s_waitcnt lgkmcnt(0)
  v_mov_b32 v248, 0xff800000
  s_mov_b32 s58, 0
L_fb0_a:
  buffer_load_dwordx4 v[88:91], v2, s[44:47], s58 offen sc1
  s_waitcnt vmcnt(0)
  v_mfma_f32_32x32x16_bf16 v[16:31], v[88:91], v[80:83], 0
  s_nop 15
  v_max3_f32 v248, v248, v16, v17
  v_max3_f32 v248, v248, v18, v19
  v_max3_f32 v248, v248, v20, v21
  v_max3_f32 v248, v248, v22, v23
  v_max3_f32 v248, v248, v24, v25
  v_max3_f32 v248, v248, v26, v27
  v_max3_f32 v248, v248, v28, v29
  v_max3_f32 v248, v248, v30, v31
  s_add_u32 s58, s58, 2048
  s_cmp_lt_u32 s58, 131072
  s_cbranch_scc1 L_fb0_a
  v_mov_b32 v249, v248
  s_nop 1
  v_permlane32_swap_b32 v249, v248
  s_nop 1
  v_max_f32 v248, v248, v249
  v_sub_f32 v32, 0, v248
  v_mov_b32 v48, 0
  v_sub_f32 v33, 0, v248
  v_mov_b32 v49, 0
  v_sub_f32 v34, 0, v248
  v_mov_b32 v50, 0
  v_sub_f32 v35, 0, v248
  v_mov_b32 v51, 0
  v_sub_f32 v36, 0, v248
  v_mov_b32 v52, 0
  v_sub_f32 v37, 0, v248
  v_mov_b32 v53, 0
  v_sub_f32 v38, 0, v248
  v_mov_b32 v54, 0
  v_sub_f32 v39, 0, v248
  v_mov_b32 v55, 0
  v_sub_f32 v40, 0, v248
  v_mov_b32 v56, 0
  v_sub_f32 v41, 0, v248
  v_mov_b32 v57, 0
  v_sub_f32 v42, 0, v248
  v_mov_b32 v58, 0
  v_sub_f32 v43, 0, v248
  v_mov_b32 v59, 0
  v_sub_f32 v44, 0, v248
  v_mov_b32 v60, 0
  v_sub_f32 v45, 0, v248
  v_mov_b32 v61, 0
  v_sub_f32 v46, 0, v248
  v_mov_b32 v62, 0
  v_sub_f32 v47, 0, v248
  v_mov_b32 v63, 0
  v_and_b32 v249, 2047, v7
  s_mov_b32 s58, 0
L_fb0_b:
  buffer_load_dwordx4 v[88:91], v2, s[44:47], s58 offen sc1
  s_mov_b64 exec, s[52:53]
  buffer_load_dwordx4 v[96:99], v249, s[44:47], s58 offen sc1
  buffer_load_dwordx4 v[100:103], v249, s[44:47], s58 offen offset:512 sc1
  s_mov_b64 exec, -1
  s_waitcnt vmcnt(0)
  v_mfma_f32_32x32x16_bf16 v[16:31], v[88:91], v[80:83], v[32:47]
  s_nop 15
  v_exp_f32 v16, v16
  v_exp_f32 v17, v17
  v_exp_f32 v18, v18
  v_exp_f32 v19, v19
  v_exp_f32 v20, v20
  v_exp_f32 v21, v21
  v_exp_f32 v22, v22
  v_exp_f32 v23, v23
  v_exp_f32 v24, v24
  v_exp_f32 v25, v25
  v_exp_f32 v26, v26
  v_exp_f32 v27, v27
  v_exp_f32 v28, v28
  v_exp_f32 v29, v29
  v_exp_f32 v30, v30
  v_exp_f32 v31, v31
  s_nop 1
  v_smfmac_f32_32x32x32_bf16 v[48:63], v[96:99], v[16:23], v5
  v_smfmac_f32_32x32x32_bf16 v[48:63], v[100:103], v[24:31], v5
  s_add_u32 s58, s58, 2048
  s_cmp_lt_u32 s58, 131072
  s_nop 15
  s_cbranch_scc1 L_fb0_b
  v_rcp_f32 v58, v56
  s_nop 0
  v_pk_mul_f32 v[16:17], v[48:49], v[58:59] op_sel_hi:[1,0]
  v_pk_mul_f32 v[18:19], v[50:51], v[58:59] op_sel_hi:[1,0]
  v_pk_mul_f32 v[20:21], v[52:53], v[58:59] op_sel_hi:[1,0]
  v_pk_mul_f32 v[22:23], v[54:55], v[58:59] op_sel_hi:[1,0]
  v_cvt_pk_bf16_f32 v252, v16, v17
  v_cvt_pk_bf16_f32 v253, v18, v19
  v_cvt_pk_bf16_f32 v254, v20, v21
  v_cvt_pk_bf16_f32 v255, v22, v23
  v_min_u32 v252, -2, v252
  s_branch L_fbback0
L_far_oa0:
  buffer_store_dwordx4 v[252:255], v236, s[44:47], s58 offen sc1
  s_branch L_near_oa0
L_slow_f0_0:
  s_mov_b32 s76, 0
L_slowl_f0_0:
  buffer_load_dwordx4 v[144:147], v2, s[44:47], s77 offen sc1
  buffer_load_dwordx4 v[148:151], v2, s[44:47], s77 offen offset:1024 sc1
  buffer_load_dwordx4 v[152:155], v2, s[44:47], s77 offen offset:2048 sc1
  buffer_load_dwordx4 v[156:159], v2, s[44:47], s77 offen offset:3072 sc1
  s_add_u32 s76, s76, 1
  s_waitcnt vmcnt(0)
  v_max3_u32 v15, v144, v148, v152
  v_max_u32 v15, v15, v156
  v_cmp_eq_u32 vcc, -1, v15
  s_cmp_gt_u32 s76, 0x100000
  s_cbranch_vccz L_back_f0_0
  s_cbranch_scc1 L_back_f0_0
  s_branch L_slowl_f0_0
L_slow_f0_1:
  s_mov_b32 s76, 0
L_slowl_f0_1:
  buffer_load_dwordx4 v[160:163], v2, s[44:47], s8 offen sc1
  buffer_load_dwordx4 v[164:167], v2, s[44:47], s8 offen offset:1024 sc1
  buffer_load_dwordx4 v[168:171], v2, s[44:47], s8 offen offset:2048 sc1
  buffer_load_dwordx4 v[172:175], v2, s[44:47], s8 offen offset:3072 sc1
  s_add_u32 s76, s76, 1
  s_waitcnt vmcnt(0)
  v_max3_u32 v15, v160, v164, v168
  v_max_u32 v15, v15, v172
  v_cmp_eq_u32 vcc, -1, v15
  s_cmp_gt_u32 s76, 0x100000
  s_cbranch_vccz L_back_f0_1
  s_cbranch_scc1 L_back_f0_1
  s_branch L_slowl_f0_1
L_wb_B1:
  buffer_wbl2 sc1
  s_branch L_wbb_B1
L_slow_f0_2:
  s_mov_b32 s76, 0
L_slowl_f0_2:
  buffer_load_dwordx4 v[176:179], v2, s[44:47], s9 offen sc1
  buffer_load_dwordx4 v[180:183], v2, s[44:47], s9 offen offset:1024 sc1
  buffer_load_dwordx4 v[184:187], v2, s[44:47], s9 offen offset:2048 sc1
  buffer_load_dwordx4 v[188:191], v2, s[44:47], s9 offen offset:3072 sc1
  s_add_u32 s76, s76, 1
  s_waitcnt vmcnt(0)
  v_max3_u32 v15, v176, v180, v184
  v_max_u32 v15, v15, v188
  v_cmp_eq_u32 vcc, -1, v15
  s_cmp_gt_u32 s76, 0x100000
  s_cbranch_vccz L_back_f0_2
  s_cbranch_scc1 L_back_f0_2
  s_branch L_slowl_f0_2
L_slow_f0_3:
  s_mov_b32 s76, 0
L_slowl_f0_3:
  buffer_load_dwordx4 v[192:195], v2, s[44:47], s10 offen sc1
  buffer_load_dwordx4 v[196:199], v2, s[44:47], s10 offen offset:1024 sc1
  buffer_load_dwordx4 v[200:203], v2, s[44:47], s10 offen offset:2048 sc1
  buffer_load_dwordx4 v[204:207], v2, s[44:47], s10 offen offset:3072 sc1
  s_add_u32 s76, s76, 1
  s_waitcnt vmcnt(0)
  v_max3_u32 v15, v192, v196, v200
  v_max_u32 v15, v15, v204
  v_cmp_eq_u32 vcc, -1, v15
  s_cmp_gt_u32 s76, 0x100000
  s_cbranch_vccz L_back_f0_3
  s_cbranch_scc1 L_back_f0_3
  s_branch L_slowl_f0_3
L_slow_kv1:
  s_mov_b32 s76, 0
L_slowl_kv1:
  s_add_u32 m0, s48, 8192
  s_add_u32 s67, s48, 8192
  buffer_load_dwordx4 v2, s[44:47], s67 offen sc1 lds
  buffer_load_dwordx4 v2, s[44:47], s67 offen offset:1024 sc1 lds
  s_add_u32 m0, s48, 16384
  s_add_u32 s67, s48, 16384
  buffer_load_dwordx4 v2, s[44:47], s67 offen sc1 lds
  buffer_load_dwordx4 v2, s[44:47], s67 offen offset:1024 sc1 lds
  s_add_u32 m0, s48, 24576
  s_add_u32 s67, s48, 24576
  buffer_load_dwordx4 v2, s[44:47], s67 offen sc1 lds
  buffer_load_dwordx4 v2, s[44:47], s67 offen offset:1024 sc1 lds
  s_add_u32 s76, s76, 1
  s_waitcnt vmcnt(0)
  ds_read_b128 v[112:115], v210 offset:8192
  ds_read_b128 v[116:119], v210 offset:9216
  ds_read_b128 v[120:123], v210 offset:16384
  ds_read_b128 v[124:127], v210 offset:17408
  ds_read_b128 v[128:131], v210 offset:24576
  ds_read_b128 v[132:135], v210 offset:25600
  s_waitcnt lgkmcnt(0)
  v_max3_u32 v15, v112, v114, v116
  v_max3_u32 v15, v15, v118, v134
  v_max3_u32 v15, v15, v120, v132
  v_max3_u32 v15, v15, v122, v130
  v_max3_u32 v15, v15, v124, v128
  v_max3_u32 v15, v15, v126, v126
  v_cmp_eq_u32 vcc, -1, v15
  s_cmp_gt_u32 s76, 0x100000
  s_cbranch_vccz L_back_kv1
  s_cbranch_scc1 L_back_kv1
  s_branch L_slowl_kv1
L_far_ca1:
  buffer_store_dwordx4 v[136:139], v236, s[44:47], s58 offen sc1
  s_branch L_near_ca1
L_far_cp:
  buffer_store_dwordx4 v[136:139], v2, s[44:47], s50 offen sc1
  s_branch L_near_cp
L_far_cb1:
  buffer_store_dwordx4 v[136:139], v236, s[44:47], s58 offen sc1
  s_branch L_near_cb1
L_slow_pm1_0:
  s_mov_b32 s76, 0
L_slowl_pm1_0:
  buffer_load_dwordx4 v[144:147], v2, s[44:47], s73 offen sc1
  buffer_load_dwordx4 v[148:151], v2, s[44:47], s73 offen offset:1024 sc1
  buffer_load_dwordx4 v[152:155], v2, s[44:47], s73 offen offset:2048 sc1
  buffer_load_dwordx4 v[156:159], v2, s[44:47], s73 offen offset:3072 sc1
  s_add_u32 s76, s76, 1
  s_waitcnt vmcnt(0)
  v_max3_u32 v15, v144, v148, v152
  v_max_u32 v15, v15, v156
  v_cmp_eq_u32 vcc, -1, v15
  s_cmp_gt_u32 s76, 0x100000
  s_cbranch_vccz L_back_pm1_0
  s_cbranch_scc1 L_back_pm1_0
  s_branch L_slowl_pm1_0
L_far_p2:
  buffer_store_dwordx4 v[112:115], v2, s[44:47], s50 offen sc1
  s_branch L_near_p2
L_slow_pm1_1:
  s_mov_b32 s76, 0
L_slowl_pm1_1:
  buffer_load_dwordx4 v[160:163], v2, s[44:47], s75 offen sc1
  buffer_load_dwordx4 v[164:167], v2, s[44:47], s75 offen offset:1024 sc1
  buffer_load_dwordx4 v[168:171], v2, s[44:47], s75 offen offset:2048 sc1
  buffer_load_dwordx4 v[172:175], v2, s[44:47], s75 offen offset:3072 sc1
  s_add_u32 s76, s76, 1
  s_waitcnt vmcnt(0)
  v_max3_u32 v15, v160, v164, v168
  v_max_u32 v15, v15, v172
  v_cmp_eq_u32 vcc, -1, v15
  s_cmp_gt_u32 s76, 0x100000
  s_cbranch_vccz L_back_pm1_1
  s_cbranch_scc1 L_back_pm1_1
  s_branch L_slowl_pm1_1
L_far_ob1:
  buffer_store_dwordx4 v[252:255], v236, s[44:47], s58 offen sc1
  s_branch L_near_ob1
L_fb1:
  s_waitcnt lgkmcnt(0)
  v_mov_b32 v248, 0xff800000
  s_mov_b32 s58, 0
L_fb1_a:
  buffer_load_dwordx4 v[88:91], v2, s[44:47], s58 offen sc1
  s_waitcnt vmcnt(0)
  v_mfma_f32_32x32x16_bf16 v[16:31], v[88:91], v[84:87], 0
  s_nop 15
  v_max3_f32 v248, v248, v16, v17
  v_max3_f32 v248, v248, v18, v19
  v_max3_f32 v248, v248, v20, v21
  v_max3_f32 v248, v248, v22, v23
  v_max3_f32 v248, v248, v24, v25
  v_max3_f32 v248, v248, v26, v27
  v_max3_f32 v248, v248, v28, v29
  v_max3_f32 v248, v248, v30, v31
  s_add_u32 s58, s58, 2048
  s_cmp_lt_u32 s58, 131072
  s_cbranch_scc1 L_fb1_a
  v_mov_b32 v249, v248
  s_nop 1
  v_permlane32_swap_b32 v249, v248
  s_nop 1
  v_max_f32 v248, v248, v249
  v_sub_f32 v32, 0, v248
  v_mov_b32 v64, 0
  v_sub_f32 v33, 0, v248
  v_mov_b32 v65, 0
  v_sub_f32 v34, 0, v248
  v_mov_b32 v66, 0
  v_sub_f32 v35, 0, v248
  v_mov_b32 v67, 0
  v_sub_f32 v36, 0, v248
  v_mov_b32 v68, 0
  v_sub_f32 v37, 0, v248
  v_mov_b32 v69, 0
  v_sub_f32 v38, 0, v248
  v_mov_b32 v70, 0
  v_sub_f32 v39, 0, v248
  v_mov_b32 v71, 0
  v_sub_f32 v40, 0, v248
  v_mov_b32 v72, 0
  v_sub_f32 v41, 0, v248
  v_mov_b32 v73, 0
  v_sub_f32 v42, 0, v248
  v_mov_b32 v74, 0
  v_sub_f32 v43, 0, v248
  v_mov_b32 v75, 0
  v_sub_f32 v44, 0, v248
  v_mov_b32 v76, 0
  v_sub_f32 v45, 0, v248
  v_mov_b32 v77, 0
  v_sub_f32 v46, 0, v248
  v_mov_b32 v78, 0
  v_sub_f32 v47, 0, v248
  v_mov_b32 v79, 0
  v_and_b32 v249, 2047, v7
  s_mov_b32 s58, 0
L_fb1_b:
  buffer_load_dwordx4 v[88:91], v2, s[44:47], s58 offen sc1
  s_mov_b64 exec, s[52:53]
  buffer_load_dwordx4 v[96:99], v249, s[44:47], s58 offen sc1
  buffer_load_dwordx4 v[100:103], v249, s[44:47], s58 offen offset:512 sc1
  s_mov_b64 exec, -1
  s_waitcnt vmcnt(0)
  v_mfma_f32_32x32x16_bf16 v[16:31], v[88:91], v[84:87], v[32:47]
  s_nop 15
  v_exp_f32 v16, v16
  v_exp_f32 v17, v17
  v_exp_f32 v18, v18
  v_exp_f32 v19, v19
  v_exp_f32 v20, v20
  v_exp_f32 v21, v21
  v_exp_f32 v22, v22
  v_exp_f32 v23, v23
  v_exp_f32 v24, v24
  v_exp_f32 v25, v25
  v_exp_f32 v26, v26
  v_exp_f32 v27, v27
  v_exp_f32 v28, v28
  v_exp_f32 v29, v29
  v_exp_f32 v30, v30
  v_exp_f32 v31, v31
  s_nop 1
  v_smfmac_f32_32x32x32_bf16 v[64:79], v[96:99], v[16:23], v5
  v_smfmac_f32_32x32x32_bf16 v[64:79], v[100:103], v[24:31], v5
  s_add_u32 s58, s58, 2048
  s_cmp_lt_u32 s58, 131072
  s_nop 15
  s_cbranch_scc1 L_fb1_b
  v_rcp_f32 v74, v72
  s_nop 0
  v_pk_mul_f32 v[16:17], v[64:65], v[74:75] op_sel_hi:[1,0]
  v_pk_mul_f32 v[18:19], v[66:67], v[74:75] op_sel_hi:[1,0]
  v_pk_mul_f32 v[20:21], v[68:69], v[74:75] op_sel_hi:[1,0]
  v_pk_mul_f32 v[22:23], v[70:71], v[74:75] op_sel_hi:[1,0]
  v_cvt_pk_bf16_f32 v252, v16, v17
  v_cvt_pk_bf16_f32 v253, v18, v19
  v_cvt_pk_bf16_f32 v254, v20, v21
  v_cvt_pk_bf16_f32 v255, v22, v23
  v_min_u32 v252, -2, v252
  s_branch L_fbback1
L_far_oa1:
  buffer_store_dwordx4 v[252:255], v236, s[44:47], s58 offen sc1
  s_branch L_near_oa1
L_slow_f1_0:
  s_mov_b32 s76, 0
L_slowl_f1_0:
  buffer_load_dwordx4 v[16:19], v2, s[44:47], s77 offen sc1
  buffer_load_dwordx4 v[20:23], v2, s[44:47], s77 offen offset:1024 sc1
  buffer_load_dwordx4 v[24:27], v2, s[44:47], s77 offen offset:2048 sc1
  buffer_load_dwordx4 v[28:31], v2, s[44:47], s77 offen offset:3072 sc1
  s_add_u32 s76, s76, 1
  s_waitcnt vmcnt(0)
  v_max3_u32 v15, v16, v20, v24
  v_max_u32 v15, v15, v28
  v_cmp_eq_u32 vcc, -1, v15
  s_cmp_gt_u32 s76, 0x100000
  s_cbranch_vccz L_back_f1_0
  s_cbranch_scc1 L_back_f1_0
  s_branch L_slowl_f1_0
L_slow_f1_1:
  s_mov_b32 s76, 0
L_slowl_f1_1:
  buffer_load_dwordx4 v[32:35], v2, s[44:47], s8 offen sc1
  buffer_load_dwordx4 v[36:39], v2, s[44:47], s8 offen offset:1024 sc1
  buffer_load_dwordx4 v[40:43], v2, s[44:47], s8 offen offset:2048 sc1
  buffer_load_dwordx4 v[44:47], v2, s[44:47], s8 offen offset:3072 sc1
  s_add_u32 s76, s76, 1
  s_waitcnt vmcnt(0)
  v_max3_u32 v15, v32, v36, v40
  v_max_u32 v15, v15, v44
  v_cmp_eq_u32 vcc, -1, v15
  s_cmp_gt_u32 s76, 0x100000
  s_cbranch_vccz L_back_f1_1
  s_cbranch_scc1 L_back_f1_1
  s_branch L_slowl_f1_1
L_slow_f1_2:
  s_mov_b32 s76, 0
L_slowl_f1_2:
  buffer_load_dwordx4 v[48:51], v2, s[44:47], s9 offen sc1
  buffer_load_dwordx4 v[52:55], v2, s[44:47], s9 offen offset:1024 sc1
  buffer_load_dwordx4 v[56:59], v2, s[44:47], s9 offen offset:2048 sc1
  buffer_load_dwordx4 v[60:63], v2, s[44:47], s9 offen offset:3072 sc1
  s_add_u32 s76, s76, 1
  s_waitcnt vmcnt(0)
  v_max3_u32 v15, v48, v52, v56
  v_max_u32 v15, v15, v60
  v_cmp_eq_u32 vcc, -1, v15
  s_cmp_gt_u32 s76, 0x100000
  s_cbranch_vccz L_back_f1_2
  s_cbranch_scc1 L_back_f1_2
  s_branch L_slowl_f1_2
L_slow_f1_3:
  s_mov_b32 s76, 0
L_slowl_f1_3:
  buffer_load_dwordx4 v[64:67], v2, s[44:47], s10 offen sc1
  buffer_load_dwordx4 v[68:71], v2, s[44:47], s10 offen offset:1024 sc1
  buffer_load_dwordx4 v[72:75], v2, s[44:47], s10 offen offset:2048 sc1
  buffer_load_dwordx4 v[76:79], v2, s[44:47], s10 offen offset:3072 sc1
  s_add_u32 s76, s76, 1
  s_waitcnt vmcnt(0)
  v_max3_u32 v15, v64, v68, v72
  v_max_u32 v15, v15, v76
  v_cmp_eq_u32 vcc, -1, v15
  s_cmp_gt_u32 s76, 0x100000
  s_cbranch_vccz L_back_f1_3
  s_cbranch_scc1 L_back_f1_3
  s_branch L_slowl_f1_3
L_role1b:
  s_cbranch_execz L_padstart2
  s_waitcnt vmcnt(8)
  ds_read_b128 v[112:115], v210 offset:0
  ds_read_b128 v[116:119], v210 offset:1024
  s_waitcnt lgkmcnt(0)
  v_max3_u32 v15, v112, v114, v116
  v_max3_u32 v15, v15, v118, v118
  v_cmp_eq_u32 vcc, -1, v15
  s_nop 0
  s_cbranch_vccnz L_slow_kv0
L_back_kv0:
  v_add_u32 v226, s56, v226
  v_add_u32 v227, s56, v227
  s_barrier
  ds_read_b128 v[88:91], v6
  ds_read_b128 v[92:95], v6 offset:4096
  s_mov_b64 exec, s[52:53]
  ds_read_b128 v[96:99], v7
  ds_read_b128 v[100:103], v7 offset:512
  s_mov_b64 exec, -1
  s_setprio 3
  s_barrier
  ds_read_b128 v[80:83], v241 offset:16384
  ds_read_b128 v[84:87], v241 offset:17408
  s_waitcnt lgkmcnt(1)
  v_mfma_f32_32x32x16_bf16 v[16:31], v[88:91], v[80:83], 0
  s_waitcnt lgkmcnt(0)
  v_mfma_f32_32x32x16_bf16 v[32:47], v[88:91], v[84:87], 0
  s_waitcnt vmcnt(2)
  ds_read_b128 v[112:115], v210 offset:8192
  ds_read_b128 v[116:119], v210 offset:9216
  ds_read_b128 v[120:123], v210 offset:16384
  ds_read_b128 v[124:127], v210 offset:17408
  ds_read_b128 v[128:131], v210 offset:24576
  ds_read_b128 v[132:135], v210 offset:25600
  s_waitcnt lgkmcnt(0)
  v_max3_u32 v15, v112, v114, v116
  v_max3_u32 v15, v15, v118, v134
  v_max3_u32 v15, v15, v120, v132
  v_max3_u32 v15, v15, v122, v130
  v_max3_u32 v15, v15, v124, v128
  v_max3_u32 v15, v15, v126, v126
  v_cmp_eq_u32 vcc, -1, v15
  s_nop 0
  s_cbranch_vccnz L_slow_kv1
L_back_kv1:
  s_barrier
  v_exp_f32 v16, v16
  v_exp_f32 v17, v17
  v_exp_f32 v18, v18
  v_exp_f32 v19, v19
  v_exp_f32 v20, v20
  v_exp_f32 v21, v21
  v_exp_f32 v22, v22
  v_exp_f32 v23, v23
  v_exp_f32 v24, v24
  v_exp_f32 v25, v25
  v_exp_f32 v26, v26
  v_exp_f32 v27, v27
  v_exp_f32 v28, v28
  v_exp_f32 v29, v29
  v_exp_f32 v30, v30
  v_exp_f32 v31, v31
  v_exp_f32 v32, v32
  v_exp_f32 v33, v33
  v_exp_f32 v34, v34
  v_exp_f32 v35, v35
  v_exp_f32 v36, v36
  v_exp_f32 v37, v37
  v_exp_f32 v38, v38
  v_exp_f32 v39, v39
  v_exp_f32 v40, v40
  v_exp_f32 v41, v41
  v_exp_f32 v42, v42
  v_exp_f32 v43, v43
  v_exp_f32 v44, v44
  v_exp_f32 v45, v45
  v_exp_f32 v46, v46
  v_exp_f32 v47, v47
  s_setprio 3
  v_smfmac_f32_32x32x32_bf16 v[48:63], v[96:99], v[16:23], v5
  v_smfmac_f32_32x32x32_bf16 v[48:63], v[100:103], v[24:31], v5
  s_add_u32 s8, s77, 4096
  s_add_u32 s9, s77, 8192
  s_add_u32 s10, s77, 12288
  v_smfmac_f32_32x32x32_bf16 v[64:79], v[100:103], v[40:47], v5
  s_mov_b32 s12, 0x3fb8aa3b
  s_mov_b32 s13, s12
  s_mov_b32 s16, 0x358637bd
  s_mov_b32 s17, s16
  v_smfmac_f32_32x32x32_bf16 v[64:79], v[96:99], v[32:39], v5
  s_mov_b64 exec, s[52:53]
  ds_read_b128 v[104:107], v7 offset:4096
  ds_read_b128 v[108:111], v7 offset:4608
  s_mov_b64 exec, -1
  v_mfma_f32_32x32x16_bf16 v[16:31], v[92:95], v[80:83], 0
  ds_read_b128 v[88:91], v6 offset:8192
  v_mfma_f32_32x32x16_bf16 v[32:47], v[92:95], v[84:87], 0
  s_nop 9
  s_setprio 0
  v_exp_f32 v16, v16
  s_setprio 2
  v_exp_f32 v17, v17
  v_exp_f32 v18, v18
  v_exp_f32 v19, v19
  v_exp_f32 v20, v20
  v_exp_f32 v21, v21
  v_exp_f32 v22, v22
  v_exp_f32 v23, v23
  v_exp_f32 v24, v24
  v_exp_f32 v25, v25
  v_exp_f32 v26, v26
  v_exp_f32 v27, v27
  v_exp_f32 v28, v28
  v_exp_f32 v29, v29
  v_exp_f32 v30, v30
  v_exp_f32 v31, v31
  v_exp_f32 v32, v32
  v_exp_f32 v33, v33
  v_exp_f32 v34, v34
  v_exp_f32 v35, v35
  v_exp_f32 v36, v36
  v_exp_f32 v37, v37
  v_exp_f32 v38, v38
  v_exp_f32 v39, v39
  v_exp_f32 v40, v40
  v_exp_f32 v41, v41
  v_exp_f32 v42, v42
  v_exp_f32 v43, v43
  v_exp_f32 v44, v44
  v_exp_f32 v45, v45
  v_exp_f32 v46, v46
  v_exp_f32 v47, v47
  s_setprio 3
  s_waitcnt lgkmcnt(0)
  v_smfmac_f32_32x32x32_bf16 v[48:63], v[104:107], v[16:23], v5
  v_smfmac_f32_32x32x32_bf16 v[48:63], v[108:111], v[24:31], v5
  s_add_u32 m0, s57, 32768
  s_mov_b32 s58, 0
  buffer_load_dwordx4 v10, s[24:27], s58 offen lds
  v_smfmac_f32_32x32x32_bf16 v[64:79], v[108:111], v[40:47], v5
  s_add_u32 m0, s57, 40960
  s_mov_b32 s58, 65536
  buffer_load_dwordx4 v10, s[24:27], s58 offen lds
  v_smfmac_f32_32x32x32_bf16 v[64:79], v[104:107], v[32:39], v5
  s_mov_b64 exec, s[52:53]
  ds_read_b128 v[96:99], v7 offset:8192
  ds_read_b128 v[100:103], v7 offset:8704
  s_mov_b64 exec, -1
  v_mfma_f32_32x32x16_bf16 v[16:31], v[88:91], v[80:83], 0
  ds_read_b128 v[92:95], v6 offset:12288
  s_add_u32 m0, s57, 98304
  s_mov_b32 s58, 0
  buffer_load_dwordx4 v12, s[28:31], s58 offen lds
  v_mfma_f32_32x32x16_bf16 v[32:47], v[88:91], v[84:87], 0
  s_add_u32 m0, s57, 106496
  s_mov_b32 s58, 0
  buffer_load_dwordx4 v11, s[28:31], s58 offen lds
  s_nop 9
  s_barrier
  v_exp_f32 v16, v16
  v_exp_f32 v17, v17
  v_exp_f32 v18, v18
  v_exp_f32 v19, v19
  v_exp_f32 v20, v20
  v_exp_f32 v21, v21
  v_exp_f32 v22, v22
  v_exp_f32 v23, v23
  v_exp_f32 v24, v24
  v_exp_f32 v25, v25
  v_exp_f32 v26, v26
  v_exp_f32 v27, v27
  v_exp_f32 v28, v28
  v_exp_f32 v29, v29
  v_exp_f32 v30, v30
  v_exp_f32 v31, v31
  v_exp_f32 v32, v32
  v_exp_f32 v33, v33
  v_exp_f32 v34, v34
  v_exp_f32 v35, v35
  v_exp_f32 v36, v36
  v_exp_f32 v37, v37
  v_exp_f32 v38, v38
  v_exp_f32 v39, v39
  v_exp_f32 v40, v40
  v_exp_f32 v41, v41
  v_exp_f32 v42, v42
  v_exp_f32 v43, v43
  v_exp_f32 v44, v44
  v_exp_f32 v45, v45
  v_exp_f32 v46, v46
  v_exp_f32 v47, v47
  s_setprio 3
  s_waitcnt lgkmcnt(0)
  v_smfmac_f32_32x32x32_bf16 v[48:63], v[96:99], v[16:23], v5
  v_smfmac_f32_32x32x32_bf16 v[48:63], v[100:103], v[24:31], v5
  v_smfmac_f32_32x32x32_bf16 v[64:79], v[100:103], v[40:47], v5
  v_smfmac_f32_32x32x32_bf16 v[64:79], v[96:99], v[32:39], v5
  s_mov_b64 exec, s[52:53]
  ds_read_b128 v[104:107], v7 offset:12288
  ds_read_b128 v[108:111], v7 offset:12800
  s_mov_b64 exec, -1
  v_mfma_f32_32x32x16_bf16 v[16:31], v[92:95], v[80:83], 0
  ds_read_b128 v[88:91], v6 offset:16384
  s_add_u32 m0, s57, 49152
  s_mov_b32 s58, 128
  buffer_load_dwordx4 v10, s[24:27], s58 offen lds
  v_mfma_f32_32x32x16_bf16 v[32:47], v[92:95], v[84:87], 0
  s_add_u32 m0, s57, 57344
  s_mov_b32 s58, 65664
  buffer_load_dwordx4 v10, s[24:27], s58 offen lds
  s_nop 9
  s_setprio 0
  v_exp_f32 v16, v16
  s_setprio 2
  v_exp_f32 v17, v17
  v_exp_f32 v18, v18
  v_exp_f32 v19, v19
  v_exp_f32 v20, v20
  v_exp_f32 v21, v21
  v_exp_f32 v22, v22
  v_exp_f32 v23, v23
  v_exp_f32 v24, v24
  v_exp_f32 v25, v25
  v_exp_f32 v26, v26
  v_exp_f32 v27, v27
  v_exp_f32 v28, v28
  v_exp_f32 v29, v29
  v_exp_f32 v30, v30
  v_exp_f32 v31, v31
  v_exp_f32 v32, v32
  v_exp_f32 v33, v33
  v_exp_f32 v34, v34
  v_exp_f32 v35, v35
  v_exp_f32 v36, v36
  v_exp_f32 v37, v37
  v_exp_f32 v38, v38
  v_exp_f32 v39, v39
  v_exp_f32 v40, v40
  v_exp_f32 v41, v41
  v_exp_f32 v42, v42
  v_exp_f32 v43, v43
  v_exp_f32 v44, v44
  v_exp_f32 v45, v45
  v_exp_f32 v46, v46
  v_exp_f32 v47, v47
  s_setprio 3
  s_waitcnt lgkmcnt(0)
  v_smfmac_f32_32x32x32_bf16 v[48:63], v[104:107], v[16:23], v5
  v_smfmac_f32_32x32x32_bf16 v[48:63], v[108:111], v[24:31], v5
  v_smfmac_f32_32x32x32_bf16 v[64:79], v[108:111], v[40:47], v5
  v_smfmac_f32_32x32x32_bf16 v[64:79], v[104:107], v[32:39], v5
  s_mov_b64 exec, s[52:53]
  ds_read_b128 v[96:99], v7 offset:16384
  ds_read_b128 v[100:103], v7 offset:16896
  s_mov_b64 exec, -1
  v_mfma_f32_32x32x16_bf16 v[16:31], v[88:91], v[80:83], 0
  ds_read_b128 v[92:95], v6 offset:20480
  s_add_u32 m0, s57, 114688
  s_mov_b32 s58, 196608
  buffer_load_dwordx4 v12, s[28:31], s58 offen lds
  v_mfma_f32_32x32x16_bf16 v[32:47], v[88:91], v[84:87], 0
  s_add_u32 m0, s57, 122880
  s_mov_b32 s58, 196608
  buffer_load_dwordx4 v11, s[28:31], s58 offen lds
  s_nop 9
  s_waitcnt vmcnt(4)
  s_barrier
  v_exp_f32 v16, v16
  v_exp_f32 v17, v17
  v_exp_f32 v18, v18
  v_exp_f32 v19, v19
  v_exp_f32 v20, v20
  v_exp_f32 v21, v21
  v_exp_f32 v22, v22
  v_exp_f32 v23, v23
  v_exp_f32 v24, v24
  v_exp_f32 v25, v25
  v_exp_f32 v26, v26
  v_exp_f32 v27, v27
  v_exp_f32 v28, v28
  v_exp_f32 v29, v29
  v_exp_f32 v30, v30
  v_exp_f32 v31, v31
  v_exp_f32 v32, v32
  v_exp_f32 v33, v33
  v_exp_f32 v34, v34
  v_exp_f32 v35, v35
  v_exp_f32 v36, v36
  v_exp_f32 v37, v37
  v_exp_f32 v38, v38
  v_exp_f32 v39, v39
  v_exp_f32 v40, v40
  v_exp_f32 v41, v41
  v_exp_f32 v42, v42
  v_exp_f32 v43, v43
  v_exp_f32 v44, v44
  v_exp_f32 v45, v45
  v_exp_f32 v46, v46
  v_exp_f32 v47, v47
  s_setprio 3
  s_waitcnt lgkmcnt(0)
  v_smfmac_f32_32x32x32_bf16 v[48:63], v[96:99], v[16:23], v5
  ds_read_b128 v[128:131], v228 offset:0
  ds_read_b64_tr_b16 v[132:133], v9 offset:0
  ds_read_b64_tr_b16 v[134:135], v9 offset:512
  v_smfmac_f32_32x32x32_bf16 v[48:63], v[100:103], v[24:31], v5
  ds_read_b128 v[176:179], v229 offset:0
  ds_read_b64_tr_b16 v[180:181], v9 offset:2048
  ds_read_b64_tr_b16 v[182:183], v9 offset:2560
  v_smfmac_f32_32x32x32_bf16 v[64:79], v[100:103], v[40:47], v5
  ds_read_b128 v[184:187], v226 offset:0
  ds_read_b64_tr_b16 v[188:189], v8 offset:12288
  ds_read_b64_tr_b16 v[190:191], v8 offset:12800
  v_smfmac_f32_32x32x32_bf16 v[64:79], v[96:99], v[32:39], v5
  s_mov_b64 exec, s[52:53]
  ds_read_b128 v[104:107], v7 offset:20480
  ds_read_b128 v[108:111], v7 offset:20992
  s_mov_b64 exec, -1
  s_add_u32 m0, s57, 0
  s_mov_b32 s58, 32768
  buffer_load_dwordx4 v14, s[44:47], s58 offen sc1 lds
  v_mfma_f32_32x32x16_bf16 v[16:31], v[92:95], v[80:83], 0
  ds_read_b128 v[88:91], v6 offset:24576
  s_add_u32 m0, s57, 65536
  s_mov_b32 s58, 256
  buffer_load_dwordx4 v10, s[24:27], s58 offen lds
  v_mfma_f32_32x32x16_bf16 v[32:47], v[92:95], v[84:87], 0
  s_add_u32 m0, s57, 73728
  s_mov_b32 s58, 65792
  buffer_load_dwordx4 v10, s[24:27], s58 offen lds
  s_waitcnt lgkmcnt(3)
  v_mfma_f32_32x32x16_bf16 v[112:127], v[128:131], v[132:135], 0
  v_mfma_f32_32x32x16_bf16 v[112:127], v[176:179], v[180:183], v[112:127]
  v_mfma_f32_32x32x16_bf16 v[208:223], v[188:191], v[184:187], 0
  s_setprio 0
  v_exp_f32 v16, v16
  s_setprio 2
  v_exp_f32 v17, v17
  v_exp_f32 v18, v18
  v_exp_f32 v19, v19
  v_exp_f32 v20, v20
  v_exp_f32 v21, v21
  v_exp_f32 v22, v22
  v_exp_f32 v23, v23
  v_exp_f32 v24, v24
  v_exp_f32 v25, v25
  v_exp_f32 v26, v26
  v_exp_f32 v27, v27
  v_exp_f32 v28, v28
  v_exp_f32 v29, v29
  v_exp_f32 v30, v30
  v_exp_f32 v31, v31
  v_exp_f32 v32, v32
  v_exp_f32 v33, v33
  v_exp_f32 v34, v34
  v_exp_f32 v35, v35
  v_exp_f32 v36, v36
  v_exp_f32 v37, v37
  v_exp_f32 v38, v38
  v_exp_f32 v39, v39
  v_exp_f32 v40, v40
  v_exp_f32 v41, v41
  v_exp_f32 v42, v42
  v_exp_f32 v43, v43
  v_exp_f32 v44, v44
  v_exp_f32 v45, v45
  v_exp_f32 v46, v46
  v_exp_f32 v47, v47
  s_setprio 3
  s_waitcnt lgkmcnt(0)
  v_smfmac_f32_32x32x32_bf16 v[48:63], v[104:107], v[16:23], v5
  ds_read_b128 v[128:131], v230 offset:0
  ds_read_b64_tr_b16 v[132:133], v9 offset:4096
  ds_read_b64_tr_b16 v[134:135], v9 offset:4608
  v_smfmac_f32_32x32x32_bf16 v[48:63], v[108:111], v[24:31], v5
  ds_read_b128 v[176:179], v231 offset:0
  ds_read_b64_tr_b16 v[180:181], v9 offset:6144
  ds_read_b64_tr_b16 v[182:183], v9 offset:6656
  v_smfmac_f32_32x32x32_bf16 v[64:79], v[108:111], v[40:47], v5
  ds_read_b128 v[184:187], v227 offset:0
  ds_read_b64_tr_b16 v[188:189], v8 offset:14336
  ds_read_b64_tr_b16 v[190:191], v8 offset:14848
  v_smfmac_f32_32x32x32_bf16 v[64:79], v[104:107], v[32:39], v5
  s_mov_b64 exec, s[52:53]
  ds_read_b128 v[96:99], v7 offset:24576
  ds_read_b128 v[100:103], v7 offset:25088
  s_mov_b64 exec, -1
  s_add_u32 m0, s57, 8192
  s_mov_b32 s58, 40960
  buffer_load_dwordx4 v14, s[44:47], s58 offen sc1 lds
  v_mfma_f32_32x32x16_bf16 v[16:31], v[88:91], v[80:83], 0
  ds_read_b128 v[92:95], v6 offset:28672
L_pad3:
  s_cbranch_execz L_padret
  s_add_u32 m0, s57, 131072
  s_mov_b32 s58, 393216
  buffer_load_dwordx4 v12, s[28:31], s58 offen lds
  v_mfma_f32_32x32x16_bf16 v[32:47], v[88:91], v[84:87], 0
  s_add_u32 m0, s57, 139264
  s_mov_b32 s58, 393216
  buffer_load_dwordx4 v11, s[28:31], s58 offen lds
  s_waitcnt lgkmcnt(3)
  v_mfma_f32_32x32x16_bf16 v[112:127], v[128:131], v[132:135], v[112:127]
  v_mfma_f32_32x32x16_bf16 v[112:127], v[176:179], v[180:183], v[112:127]
  v_mfma_f32_32x32x16_bf16 v[208:223], v[188:191], v[184:187], v[208:223]
  s_waitcnt vmcnt(5)
  s_barrier
  v_exp_f32 v16, v16
  v_exp_f32 v17, v17
  v_exp_f32 v18, v18
  v_exp_f32 v19, v19
  v_exp_f32 v20, v20
  v_exp_f32 v21, v21
  v_exp_f32 v22, v22
  v_exp_f32 v23, v23
  v_exp_f32 v24, v24
  v_exp_f32 v25, v25
  v_exp_f32 v26, v26
  v_exp_f32 v27, v27
  v_exp_f32 v28, v28
  v_exp_f32 v29, v29
  v_exp_f32 v30, v30
  v_exp_f32 v31, v31
  v_exp_f32 v32, v32
  v_exp_f32 v33, v33
  v_exp_f32 v34, v34
  v_exp_f32 v35, v35
  v_exp_f32 v36, v36
  v_exp_f32 v37, v37
  v_exp_f32 v38, v38
  v_exp_f32 v39, v39
  v_exp_f32 v40, v40
  v_exp_f32 v41, v41
  v_exp_f32 v42, v42
  v_exp_f32 v43, v43
  v_exp_f32 v44, v44
  v_exp_f32 v45, v45
  v_exp_f32 v46, v46
  v_exp_f32 v47, v47
  s_setprio 3
  s_waitcnt lgkmcnt(0)
  v_smfmac_f32_32x32x32_bf16 v[48:63], v[96:99], v[16:23], v5
  ds_read_b128 v[128:131], v228 offset:16384
  ds_read_b64_tr_b16 v[132:133], v9 offset:16384
  ds_read_b64_tr_b16 v[134:135], v9 offset:16896
  v_smfmac_f32_32x32x32_bf16 v[48:63], v[100:103], v[24:31], v5
  ds_read_b128 v[176:179], v229 offset:16384
  ds_read_b64_tr_b16 v[180:181], v9 offset:18432
  ds_read_b64_tr_b16 v[182:183], v9 offset:18944
  v_smfmac_f32_32x32x32_bf16 v[64:79], v[100:103], v[40:47], v5
  ds_read_b128 v[184:187], v226 offset:16384
  ds_read_b64_tr_b16 v[188:189], v8 offset:28672
  ds_read_b64_tr_b16 v[190:191], v8 offset:29184
  v_smfmac_f32_32x32x32_bf16 v[64:79], v[96:99], v[32:39], v5
  s_mov_b64 exec, s[52:53]
  ds_read_b128 v[104:107], v7 offset:28672
  ds_read_b128 v[108:111], v7 offset:29184
  s_mov_b64 exec, -1
  buffer_load_dword v246, v246, s[44:47], 0 offen sc1
  v_mfma_f32_32x32x16_bf16 v[16:31], v[92:95], v[80:83], 0
  ds_read_b128 v[88:91], v6 offset:0
  s_add_u32 m0, s57, 81920
  s_mov_b32 s58, 384
  buffer_load_dwordx4 v10, s[24:27], s58 offen lds
  v_mfma_f32_32x32x16_bf16 v[32:47], v[92:95], v[84:87], 0
  s_add_u32 m0, s57, 90112
  s_mov_b32 s58, 65920
  buffer_load_dwordx4 v10, s[24:27], s58 offen lds
  s_waitcnt lgkmcnt(3)
  v_mfma_f32_32x32x16_bf16 v[112:127], v[128:131], v[132:135], v[112:127]
  v_mfma_f32_32x32x16_bf16 v[112:127], v[176:179], v[180:183], v[112:127]
  v_mfma_f32_32x32x16_bf16 v[208:223], v[188:191], v[184:187], v[208:223]
  s_setprio 0
  v_exp_f32 v16, v16
  s_setprio 2
  v_exp_f32 v17, v17
  v_exp_f32 v18, v18
  v_exp_f32 v19, v19
  v_exp_f32 v20, v20
  v_exp_f32 v21, v21
  v_exp_f32 v22, v22
  v_exp_f32 v23, v23
  v_exp_f32 v24, v24
  v_exp_f32 v25, v25
  v_exp_f32 v26, v26
  v_exp_f32 v27, v27
  v_exp_f32 v28, v28
  v_exp_f32 v29, v29
  v_exp_f32 v30, v30
  v_exp_f32 v31, v31
  v_exp_f32 v32, v32
  v_exp_f32 v33, v33
  v_exp_f32 v34, v34
  v_exp_f32 v35, v35
  v_exp_f32 v36, v36
  v_exp_f32 v37, v37
  v_exp_f32 v38, v38
  v_exp_f32 v39, v39
  v_exp_f32 v40, v40
  v_exp_f32 v41, v41
  v_exp_f32 v42, v42
  v_exp_f32 v43, v43
  v_exp_f32 v44, v44
  v_exp_f32 v45, v45
  v_exp_f32 v46, v46
  v_exp_f32 v47, v47
  s_setprio 3
  s_waitcnt lgkmcnt(0)
  v_smfmac_f32_32x32x32_bf16 v[48:63], v[104:107], v[16:23], v5
  ds_read_b128 v[128:131], v230 offset:16384
  ds_read_b64_tr_b16 v[132:133], v9 offset:20480
  ds_read_b64_tr_b16 v[134:135], v9 offset:20992
  v_smfmac_f32_32x32x32_bf16 v[48:63], v[108:111], v[24:31], v5
  ds_read_b128 v[176:179], v231 offset:16384
  ds_read_b64_tr_b16 v[180:181], v9 offset:22528
  ds_read_b64_tr_b16 v[182:183], v9 offset:23040
  v_smfmac_f32_32x32x32_bf16 v[64:79], v[108:111], v[40:47], v5
  ds_read_b128 v[184:187], v227 offset:16384
  ds_read_b64_tr_b16 v[188:189], v8 offset:30720
  ds_read_b64_tr_b16 v[190:191], v8 offset:31232
  v_smfmac_f32_32x32x32_bf16 v[64:79], v[104:107], v[32:39], v5
  s_mov_b64 exec, s[52:53]
  ds_read_b128 v[96:99], v7 offset:0
  ds_read_b128 v[100:103], v7 offset:512
  s_mov_b64 exec, -1
  s_add_u32 m0, s57, 16384
  s_mov_b32 s58, 49152
  buffer_load_dwordx4 v14, s[44:47], s58 offen sc1 lds
  v_mfma_f32_32x32x16_bf16 v[16:31], v[88:91], v[80:83], 0
  ds_read_b128 v[92:95], v6 offset:4096
  s_add_u32 m0, s57, 147456
  s_mov_b32 s58, 589824
  buffer_load_dwordx4 v12, s[28:31], s58 offen lds
  v_mfma_f32_32x32x16_bf16 v[32:47], v[88:91], v[84:87], 0
  s_add_u32 m0, s57, 155648
  s_mov_b32 s58, 589824
  buffer_load_dwordx4 v11, s[28:31], s58 offen lds
  s_waitcnt lgkmcnt(3)
  v_mfma_f32_32x32x16_bf16 v[112:127], v[128:131], v[132:135], v[112:127]
  s_lshl_b32 s68, s4, 3
  s_add_u32 s68, s68, s5
  s_lshl_b32 s68, s68, 2
  s_add_u32 s68, s68, s3
  s_sub_u32 s68, s68, 4
  s_lshl_b32 s67, s68, 9
  s_mov_b32 exec_hi, 0
  buffer_load_dword v198, v2, s[20:23], s67 offen
  buffer_load_dword v199, v2, s[32:35], s67 offen
  s_mov_b32 exec_hi, -1
  v_mfma_f32_32x32x16_bf16 v[112:127], v[176:179], v[180:183], v[112:127]
  v_mfma_f32_32x32x16_bf16 v[208:223], v[188:191], v[184:187], v[208:223]
  s_waitcnt vmcnt(8)
  s_barrier
  v_exp_f32 v16, v16
  v_exp_f32 v17, v17
  v_exp_f32 v18, v18
  v_exp_f32 v19, v19
  v_exp_f32 v20, v20
  v_exp_f32 v21, v21
  v_exp_f32 v22, v22
  v_exp_f32 v23, v23
  v_exp_f32 v24, v24
  v_exp_f32 v25, v25
  v_exp_f32 v26, v26
  v_exp_f32 v27, v27
  v_exp_f32 v28, v28
  v_exp_f32 v29, v29
  v_exp_f32 v30, v30
  v_exp_f32 v31, v31
  v_exp_f32 v32, v32
  v_exp_f32 v33, v33
  v_exp_f32 v34, v34
  v_exp_f32 v35, v35
  v_exp_f32 v36, v36
  v_exp_f32 v37, v37
  v_exp_f32 v38, v38
  v_exp_f32 v39, v39
  v_exp_f32 v40, v40
  v_exp_f32 v41, v41
  v_exp_f32 v42, v42
  v_exp_f32 v43, v43
  v_exp_f32 v44, v44
  v_exp_f32 v45, v45
  v_exp_f32 v46, v46
  v_exp_f32 v47, v47
  s_setprio 3
  s_waitcnt lgkmcnt(0)
  v_smfmac_f32_32x32x32_bf16 v[48:63], v[96:99], v[16:23], v5
  ds_read_b128 v[128:131], v228 offset:32768
  ds_read_b64_tr_b16 v[132:133], v9 offset:32768
  ds_read_b64_tr_b16 v[134:135], v9 offset:33280
  v_smfmac_f32_32x32x32_bf16 v[48:63], v[100:103], v[24:31], v5
  ds_read_b128 v[176:179], v229 offset:32768
  ds_read_b64_tr_b16 v[180:181], v9 offset:34816
  ds_read_b64_tr_b16 v[182:183], v9 offset:35328
  v_smfmac_f32_32x32x32_bf16 v[64:79], v[100:103], v[40:47], v5
  ds_read_b128 v[184:187], v226 offset:32768
  ds_read_b64_tr_b16 v[188:189], v8 offset:45056
  ds_read_b64_tr_b16 v[190:191], v8 offset:45568
  v_smfmac_f32_32x32x32_bf16 v[64:79], v[96:99], v[32:39], v5
  s_mov_b64 exec, s[52:53]
  ds_read_b128 v[104:107], v7 offset:4096
  ds_read_b128 v[108:111], v7 offset:4608
  s_mov_b64 exec, -1
  v_mfma_f32_32x32x16_bf16 v[16:31], v[92:95], v[80:83], 0
  ds_read_b128 v[88:91], v6 offset:8192
  s_add_u32 m0, s57, 32768
  s_mov_b32 s58, 512
  buffer_load_dwordx4 v10, s[24:27], s58 offen lds
  v_mfma_f32_32x32x16_bf16 v[32:47], v[92:95], v[84:87], 0
  s_add_u32 m0, s57, 40960
  s_mov_b32 s58, 66048
  buffer_load_dwordx4 v10, s[24:27], s58 offen lds
  s_waitcnt lgkmcnt(3)
  v_mfma_f32_32x32x16_bf16 v[112:127], v[128:131], v[132:135], v[112:127]
  v_mfma_f32_32x32x16_bf16 v[112:127], v[176:179], v[180:183], v[112:127]
  v_mfma_f32_32x32x16_bf16 v[208:223], v[188:191], v[184:187], v[208:223]
  s_setprio 0
  v_exp_f32 v16, v16
  s_setprio 2
  v_exp_f32 v17, v17
  v_exp_f32 v18, v18
  v_exp_f32 v19, v19
  v_exp_f32 v20, v20
  v_exp_f32 v21, v21
  v_exp_f32 v22, v22
  v_exp_f32 v23, v23
  v_exp_f32 v24, v24
  v_exp_f32 v25, v25
  v_exp_f32 v26, v26
  v_exp_f32 v27, v27
  s_waitcnt vmcnt(9)
  v_and_b32 v246, 15, v246
  v_cmp_ne_u32 vcc, s71, v246
  v_exp_f32 v28, v28
  v_exp_f32 v29, v29
  v_exp_f32 v30, v30
  v_exp_f32 v31, v31
  v_exp_f32 v32, v32
  v_exp_f32 v33, v33
  v_exp_f32 v34, v34
  v_exp_f32 v35, v35
  v_exp_f32 v36, v36
  v_exp_f32 v37, v37
  v_exp_f32 v38, v38
  v_exp_f32 v39, v39
  v_exp_f32 v40, v40
  v_exp_f32 v41, v41
  v_exp_f32 v42, v42
  v_exp_f32 v43, v43
  v_exp_f32 v44, v44
  v_exp_f32 v45, v45
  v_exp_f32 v46, v46
  v_exp_f32 v47, v47
  s_setprio 3
  s_waitcnt lgkmcnt(0)
  v_smfmac_f32_32x32x32_bf16 v[48:63], v[104:107], v[16:23], v5
  s_or_b32 s72, vcc_lo, 0
  s_cselect_b32 s72, -1, 0
  s_and_b32 s58, s72, 1073741824
  v_or_b32 v246, s58, v2
  ds_read_b128 v[128:131], v230 offset:32768
  ds_read_b64_tr_b16 v[132:133], v9 offset:36864
  ds_read_b64_tr_b16 v[134:135], v9 offset:37376
  v_smfmac_f32_32x32x32_bf16 v[48:63], v[108:111], v[24:31], v5
  ds_read_b128 v[176:179], v231 offset:32768
  ds_read_b64_tr_b16 v[180:181], v9 offset:38912
  ds_read_b64_tr_b16 v[182:183], v9 offset:39424
  v_smfmac_f32_32x32x32_bf16 v[64:79], v[108:111], v[40:47], v5
  ds_read_b128 v[184:187], v227 offset:32768
  ds_read_b64_tr_b16 v[188:189], v8 offset:47104
  ds_read_b64_tr_b16 v[190:191], v8 offset:47616
  v_smfmac_f32_32x32x32_bf16 v[64:79], v[104:107], v[32:39], v5
  s_mov_b64 exec, s[52:53]
  ds_read_b128 v[96:99], v7 offset:8192
  ds_read_b128 v[100:103], v7 offset:8704
  s_mov_b64 exec, -1
  s_add_u32 m0, s57, 24576
  s_mov_b32 s58, 57344
  buffer_load_dwordx4 v14, s[44:47], s58 offen sc1 lds
  v_mfma_f32_32x32x16_bf16 v[16:31], v[88:91], v[80:83], 0
  ds_read_b128 v[92:95], v6 offset:12288
  s_add_u32 m0, s57, 98304
  s_mov_b32 s58, 786432
  buffer_load_dwordx4 v12, s[28:31], s58 offen lds
  v_mfma_f32_32x32x16_bf16 v[32:47], v[88:91], v[84:87], 0
  s_add_u32 m0, s57, 106496
  s_mov_b32 s58, 786432
  buffer_load_dwordx4 v11, s[28:31], s58 offen lds
  s_waitcnt lgkmcnt(3)
  v_mfma_f32_32x32x16_bf16 v[112:127], v[128:131], v[132:135], v[112:127]
  v_mfma_f32_32x32x16_bf16 v[112:127], v[176:179], v[180:183], v[112:127]
  v_mfma_f32_32x32x16_bf16 v[208:223], v[188:191], v[184:187], v[208:223]
  s_waitcnt vmcnt(7)
  s_barrier
  v_exp_f32 v16, v16
  v_exp_f32 v17, v17
  v_exp_f32 v18, v18
  v_exp_f32 v19, v19
  v_exp_f32 v20, v20
  v_exp_f32 v21, v21
  v_exp_f32 v22, v22
  v_exp_f32 v23, v23
  v_exp_f32 v24, v24
  v_exp_f32 v25, v25
  v_exp_f32 v26, v26
  v_exp_f32 v27, v27
  v_exp_f32 v28, v28
  v_exp_f32 v29, v29
  v_exp_f32 v30, v30
  v_exp_f32 v31, v31
  v_exp_f32 v32, v32
  v_exp_f32 v33, v33
  v_exp_f32 v34, v34
  v_exp_f32 v35, v35
  v_exp_f32 v36, v36
  v_exp_f32 v37, v37
  v_exp_f32 v38, v38
  v_exp_f32 v39, v39
  v_exp_f32 v40, v40
  v_exp_f32 v41, v41
  v_exp_f32 v42, v42
  v_exp_f32 v43, v43
  v_exp_f32 v44, v44
  v_exp_f32 v45, v45
  v_exp_f32 v46, v46
  v_exp_f32 v47, v47
  s_setprio 3
  s_waitcnt lgkmcnt(0)
  v_smfmac_f32_32x32x32_bf16 v[48:63], v[96:99], v[16:23], v5
  ds_read_b128 v[128:131], v228 offset:49152
  ds_read_b64_tr_b16 v[132:133], v9 offset:49152
  ds_read_b64_tr_b16 v[134:135], v9 offset:49664
  v_smfmac_f32_32x32x32_bf16 v[48:63], v[100:103], v[24:31], v5
  ds_read_b128 v[176:179], v229 offset:49152
  ds_read_b64_tr_b16 v[180:181], v9 offset:51200
  ds_read_b64_tr_b16 v[182:183], v9 offset:51712
  v_smfmac_f32_32x32x32_bf16 v[64:79], v[100:103], v[40:47], v5
  ds_read_b128 v[184:187], v226 offset:49152
  ds_read_b64_tr_b16 v[188:189], v8 offset:61440
  ds_read_b64_tr_b16 v[190:191], v8 offset:61952
  v_smfmac_f32_32x32x32_bf16 v[64:79], v[96:99], v[32:39], v5
  s_mov_b64 exec, s[52:53]
  ds_read_b128 v[104:107], v7 offset:12288
  ds_read_b128 v[108:111], v7 offset:12800
  s_mov_b64 exec, -1
  s_mov_b32 s58, 1048576
  s_cmp_lg_u32 s72, 0
  s_cbranch_scc1 L_far_ca1
  buffer_store_dwordx4 v[136:139], v236, s[44:47], s58 offen
L_near_ca1:
  v_mfma_f32_32x32x16_bf16 v[16:31], v[92:95], v[80:83], 0
  ds_read_b128 v[88:91], v6 offset:16384
  s_add_u32 m0, s57, 49152
  s_mov_b32 s58, 640
  buffer_load_dwordx4 v10, s[24:27], s58 offen lds
  v_mfma_f32_32x32x16_bf16 v[32:47], v[92:95], v[84:87], 0
  s_add_u32 m0, s57, 57344
  s_mov_b32 s58, 66176
  buffer_load_dwordx4 v10, s[24:27], s58 offen lds
  s_waitcnt lgkmcnt(3)
  v_mfma_f32_32x32x16_bf16 v[112:127], v[128:131], v[132:135], v[112:127]
  v_mfma_f32_32x32x16_bf16 v[112:127], v[176:179], v[180:183], v[112:127]
  v_mfma_f32_32x32x16_bf16 v[208:223], v[188:191], v[184:187], v[208:223]
  s_setprio 0
  v_exp_f32 v16, v16
  s_setprio 2
  v_exp_f32 v17, v17
  v_exp_f32 v18, v18
  v_exp_f32 v19, v19
  v_exp_f32 v20, v20
  v_exp_f32 v21, v21
  v_exp_f32 v22, v22
  v_exp_f32 v23, v23
  v_exp_f32 v24, v24
  v_exp_f32 v25, v25
  v_exp_f32 v26, v26
  v_exp_f32 v27, v27
  v_exp_f32 v28, v28
  v_exp_f32 v29, v29
  v_exp_f32 v30, v30
  v_exp_f32 v31, v31
  v_exp_f32 v32, v32
  v_exp_f32 v33, v33
  v_exp_f32 v34, v34
  v_exp_f32 v35, v35
  v_exp_f32 v36, v36
  v_exp_f32 v37, v37
  v_exp_f32 v38, v38
  v_exp_f32 v39, v39
  v_exp_f32 v40, v40
  v_exp_f32 v41, v41
  v_exp_f32 v42, v42
  v_exp_f32 v43, v43
  v_exp_f32 v44, v44
  v_exp_f32 v45, v45
  v_exp_f32 v46, v46
  v_exp_f32 v47, v47
  s_setprio 3
  s_waitcnt lgkmcnt(0)
  v_smfmac_f32_32x32x32_bf16 v[48:63], v[104:107], v[16:23], v5
  ds_read_b128 v[128:131], v230 offset:49152
  ds_read_b64_tr_b16 v[132:133], v9 offset:53248
  ds_read_b64_tr_b16 v[134:135], v9 offset:53760
  v_smfmac_f32_32x32x32_bf16 v[48:63], v[108:111], v[24:31], v5
  ds_read_b128 v[176:179], v231 offset:49152
  ds_read_b64_tr_b16 v[180:181], v9 offset:55296
  ds_read_b64_tr_b16 v[182:183], v9 offset:55808
  v_smfmac_f32_32x32x32_bf16 v[64:79], v[108:111], v[40:47], v5
  ds_read_b128 v[184:187], v227 offset:49152
  ds_read_b64_tr_b16 v[188:189], v8 offset:63488
  ds_read_b64_tr_b16 v[190:191], v8 offset:64000
  v_smfmac_f32_32x32x32_bf16 v[64:79], v[104:107], v[32:39], v5
  s_mov_b64 exec, s[52:53]
  ds_read_b128 v[96:99], v7 offset:16384
  ds_read_b128 v[100:103], v7 offset:16896
  s_mov_b64 exec, -1
  s_add_u32 m0, s57, 0
  s_mov_b32 s58, 65536
  buffer_load_dwordx4 v14, s[44:47], s58 offen sc1 lds
  v_mfma_f32_32x32x16_bf16 v[16:31], v[88:91], v[80:83], 0
  ds_read_b128 v[92:95], v6 offset:20480
  s_add_u32 m0, s57, 114688
  s_mov_b32 s58, 983040
  buffer_load_dwordx4 v12, s[28:31], s58 offen lds
  v_mfma_f32_32x32x16_bf16 v[32:47], v[88:91], v[84:87], 0
  s_add_u32 m0, s57, 122880
  s_mov_b32 s58, 983040
  buffer_load_dwordx4 v11, s[28:31], s58 offen lds
  s_waitcnt lgkmcnt(3)
  v_mfma_f32_32x32x16_bf16 v[112:127], v[128:131], v[132:135], v[112:127]
  s_cmp_lg_u32 s72, 0
  s_cbranch_scc1 L_far_cp
  buffer_store_dwordx4 v[136:139], v2, s[44:47], s50 offen
L_near_cp:
  v_mfma_f32_32x32x16_bf16 v[112:127], v[176:179], v[180:183], v[112:127]
  v_mfma_f32_32x32x16_bf16 v[208:223], v[188:191], v[184:187], v[208:223]
  s_waitcnt vmcnt(7)
  s_barrier
  v_exp_f32 v16, v16
  v_exp_f32 v17, v17
  v_exp_f32 v18, v18
  v_exp_f32 v19, v19
  v_exp_f32 v20, v20
  v_exp_f32 v21, v21
  v_exp_f32 v22, v22
  v_exp_f32 v23, v23
  v_exp_f32 v24, v24
  v_exp_f32 v25, v25
  v_exp_f32 v26, v26
  v_exp_f32 v27, v27
  v_exp_f32 v28, v28
  v_exp_f32 v29, v29
  v_exp_f32 v30, v30
  v_exp_f32 v31, v31
  v_exp_f32 v32, v32
  v_exp_f32 v33, v33
  v_exp_f32 v34, v34
  v_exp_f32 v35, v35
  v_exp_f32 v36, v36
  v_exp_f32 v37, v37
  v_exp_f32 v38, v38
  v_exp_f32 v39, v39
  v_exp_f32 v40, v40
  v_exp_f32 v41, v41
  v_exp_f32 v42, v42
  v_exp_f32 v43, v43
  v_exp_f32 v44, v44
  v_exp_f32 v45, v45
  v_exp_f32 v46, v46
  v_exp_f32 v47, v47
  s_setprio 3
  s_waitcnt lgkmcnt(0)
  v_smfmac_f32_32x32x32_bf16 v[48:63], v[96:99], v[16:23], v5
  ds_read_b128 v[128:131], v228 offset:0
  ds_read_b64_tr_b16 v[132:133], v9 offset:0
  ds_read_b64_tr_b16 v[134:135], v9 offset:512
  v_smfmac_f32_32x32x32_bf16 v[48:63], v[100:103], v[24:31], v5
  ds_read_b128 v[176:179], v229 offset:0
  ds_read_b64_tr_b16 v[180:181], v9 offset:2048
  ds_read_b64_tr_b16 v[182:183], v9 offset:2560
  v_smfmac_f32_32x32x32_bf16 v[64:79], v[100:103], v[40:47], v5
  ds_read_b128 v[184:187], v226 offset:0
  ds_read_b64_tr_b16 v[188:189], v8 offset:12288
  ds_read_b64_tr_b16 v[190:191], v8 offset:12800
  v_smfmac_f32_32x32x32_bf16 v[64:79], v[96:99], v[32:39], v5
  s_mov_b64 exec, s[52:53]
  ds_read_b128 v[104:107], v7 offset:20480
  ds_read_b128 v[108:111], v7 offset:20992
  s_mov_b64 exec, -1
  s_mov_b32 s58, 3145728
  s_cmp_lg_u32 s72, 0
  s_cbranch_scc1 L_far_cb1
  buffer_store_dwordx4 v[136:139], v236, s[44:47], s58 offen
L_near_cb1:
  v_mfma_f32_32x32x16_bf16 v[16:31], v[92:95], v[80:83], 0
  ds_read_b128 v[88:91], v6 offset:24576
  s_add_u32 m0, s57, 65536
  s_mov_b32 s58, 768
  buffer_load_dwordx4 v10, s[24:27], s58 offen lds
  v_mfma_f32_32x32x16_bf16 v[32:47], v[92:95], v[84:87], 0
  s_add_u32 m0, s57, 73728
  s_mov_b32 s58, 66304
  buffer_load_dwordx4 v10, s[24:27], s58 offen lds
  s_waitcnt lgkmcnt(3)
  v_mfma_f32_32x32x16_bf16 v[112:127], v[128:131], v[132:135], v[112:127]
  v_mfma_f32_32x32x16_bf16 v[112:127], v[176:179], v[180:183], v[112:127]
  v_mfma_f32_32x32x16_bf16 v[208:223], v[188:191], v[184:187], v[208:223]
  s_setprio 0
  v_exp_f32 v16, v16
  s_setprio 2
  v_exp_f32 v17, v17
  v_exp_f32 v18, v18
  v_exp_f32 v19, v19
  v_exp_f32 v20, v20
  v_exp_f32 v21, v21
  v_exp_f32 v22, v22
  v_exp_f32 v23, v23
  v_exp_f32 v24, v24
  v_exp_f32 v25, v25
  v_exp_f32 v26, v26
  v_exp_f32 v27, v27
  v_exp_f32 v28, v28
  v_exp_f32 v29, v29
  v_exp_f32 v30, v30
  v_exp_f32 v31, v31
  v_exp_f32 v32, v32
  v_exp_f32 v33, v33
  v_exp_f32 v34, v34
  v_exp_f32 v35, v35
  v_exp_f32 v36, v36
  v_exp_f32 v37, v37
  v_exp_f32 v38, v38
  v_exp_f32 v39, v39
  v_exp_f32 v40, v40
  v_exp_f32 v41, v41
  v_exp_f32 v42, v42
  v_exp_f32 v43, v43
  v_exp_f32 v44, v44
  v_exp_f32 v45, v45
  v_exp_f32 v46, v46
  v_exp_f32 v47, v47
  s_setprio 3
  s_waitcnt lgkmcnt(0)
  v_smfmac_f32_32x32x32_bf16 v[48:63], v[104:107], v[16:23], v5
  ds_read_b128 v[128:131], v230 offset:0
  ds_read_b64_tr_b16 v[132:133], v9 offset:4096
  ds_read_b64_tr_b16 v[134:135], v9 offset:4608
  v_smfmac_f32_32x32x32_bf16 v[48:63], v[108:111], v[24:31], v5
  ds_read_b128 v[176:179], v231 offset:0
  ds_read_b64_tr_b16 v[180:181], v9 offset:6144
  ds_read_b64_tr_b16 v[182:183], v9 offset:6656
  v_smfmac_f32_32x32x32_bf16 v[64:79], v[108:111], v[40:47], v5
  ds_read_b128 v[184:187], v227 offset:0
  ds_read_b64_tr_b16 v[188:189], v8 offset:14336
  ds_read_b64_tr_b16 v[190:191], v8 offset:14848
  v_smfmac_f32_32x32x32_bf16 v[64:79], v[104:107], v[32:39], v5
  s_mov_b64 exec, s[52:53]
  ds_read_b128 v[96:99], v7 offset:24576
  ds_read_b128 v[100:103], v7 offset:25088
  s_mov_b64 exec, -1
  s_add_u32 m0, s57, 8192
  s_mov_b32 s58, 73728
  buffer_load_dwordx4 v14, s[44:47], s58 offen sc1 lds
  v_mfma_f32_32x32x16_bf16 v[16:31], v[88:91], v[80:83], 0
  ds_read_b128 v[92:95], v6 offset:28672
  s_add_u32 m0, s57, 131072
  s_mov_b32 s58, 1179648
  buffer_load_dwordx4 v12, s[28:31], s58 offen lds
  v_mfma_f32_32x32x16_bf16 v[32:47], v[88:91], v[84:87], 0
  s_add_u32 m0, s57, 139264
  s_mov_b32 s58, 1179648
  buffer_load_dwordx4 v11, s[28:31], s58 offen lds
  s_waitcnt lgkmcnt(3)
  v_mfma_f32_32x32x16_bf16 v[112:127], v[128:131], v[132:135], v[112:127]
  v_mfma_f32_32x32x16_bf16 v[112:127], v[176:179], v[180:183], v[112:127]
  v_mfma_f32_32x32x16_bf16 v[208:223], v[188:191], v[184:187], v[208:223]
  s_waitcnt vmcnt(5)
  s_barrier
  v_exp_f32 v16, v16
  v_exp_f32 v17, v17
  v_exp_f32 v18, v18
  v_exp_f32 v19, v19
  v_exp_f32 v20, v20
  v_exp_f32 v21, v21
  v_exp_f32 v22, v22
  v_exp_f32 v23, v23
  v_exp_f32 v24, v24
  v_exp_f32 v25, v25
  v_exp_f32 v26, v26
  v_exp_f32 v27, v27
  v_exp_f32 v28, v28
  v_exp_f32 v29, v29
  v_exp_f32 v30, v30
  v_exp_f32 v31, v31
  v_exp_f32 v32, v32
  v_exp_f32 v33, v33
  v_exp_f32 v34, v34
  v_exp_f32 v35, v35
  v_exp_f32 v36, v36
  v_exp_f32 v37, v37
  v_exp_f32 v38, v38
  v_exp_f32 v39, v39
  v_exp_f32 v40, v40
  v_exp_f32 v41, v41
  v_exp_f32 v42, v42
  v_exp_f32 v43, v43
  v_exp_f32 v44, v44
  v_exp_f32 v45, v45
  v_exp_f32 v46, v46
  v_exp_f32 v47, v47
  s_setprio 3
  s_waitcnt lgkmcnt(0)
  v_smfmac_f32_32x32x32_bf16 v[48:63], v[96:99], v[16:23], v5
  ds_read_b128 v[128:131], v228 offset:16384
  ds_read_b64_tr_b16 v[132:133], v9 offset:16384
  ds_read_b64_tr_b16 v[134:135], v9 offset:16896
  v_smfmac_f32_32x32x32_bf16 v[48:63], v[100:103], v[24:31], v5
  ds_read_b128 v[176:179], v229 offset:16384
  ds_read_b64_tr_b16 v[180:181], v9 offset:18432
  ds_read_b64_tr_b16 v[182:183], v9 offset:18944
  v_smfmac_f32_32x32x32_bf16 v[64:79], v[100:103], v[40:47], v5
  ds_read_b128 v[184:187], v226 offset:16384
  ds_read_b64_tr_b16 v[188:189], v8 offset:28672
  ds_read_b64_tr_b16 v[190:191], v8 offset:29184
  v_smfmac_f32_32x32x32_bf16 v[64:79], v[96:99], v[32:39], v5
  s_mov_b64 exec, s[52:53]
  ds_read_b128 v[104:107], v7 offset:28672
  ds_read_b128 v[108:111], v7 offset:29184
  s_mov_b64 exec, -1
  v_mfma_f32_32x32x16_bf16 v[16:31], v[92:95], v[80:83], 0
  ds_read_b128 v[88:91], v6 offset:0
  s_add_u32 m0, s57, 81920
  s_mov_b32 s58, 896
  buffer_load_dwordx4 v10, s[24:27], s58 offen lds
  v_mfma_f32_32x32x16_bf16 v[32:47], v[92:95], v[84:87], 0
  s_add_u32 m0, s57, 90112
  s_mov_b32 s58, 66432
  buffer_load_dwordx4 v10, s[24:27], s58 offen lds
  s_waitcnt lgkmcnt(3)
  v_mfma_f32_32x32x16_bf16 v[112:127], v[128:131], v[132:135], v[112:127]
  v_mfma_f32_32x32x16_bf16 v[112:127], v[176:179], v[180:183], v[112:127]
  v_mfma_f32_32x32x16_bf16 v[208:223], v[188:191], v[184:187], v[208:223]
  s_setprio 0
  v_exp_f32 v16, v16
  s_setprio 2
  v_exp_f32 v17, v17
  v_exp_f32 v18, v18
  v_exp_f32 v19, v19
  v_exp_f32 v20, v20
  v_exp_f32 v21, v21
  v_exp_f32 v22, v22
  v_exp_f32 v23, v23
  v_exp_f32 v24, v24
  v_exp_f32 v25, v25
  v_exp_f32 v26, v26
  v_exp_f32 v27, v27
  v_exp_f32 v28, v28
  v_exp_f32 v29, v29
  v_exp_f32 v30, v30
  v_exp_f32 v31, v31
  v_exp_f32 v32, v32
  v_exp_f32 v33, v33
  v_exp_f32 v34, v34
  v_exp_f32 v35, v35
  v_exp_f32 v36, v36
  v_exp_f32 v37, v37
  v_exp_f32 v38, v38
  v_exp_f32 v39, v39
  v_exp_f32 v40, v40
  v_exp_f32 v41, v41
  v_exp_f32 v42, v42
  v_exp_f32 v43, v43
  v_exp_f32 v44, v44
  v_exp_f32 v45, v45
  v_exp_f32 v46, v46
  v_exp_f32 v47, v47
  s_setprio 3
  s_waitcnt lgkmcnt(0)
  v_smfmac_f32_32x32x32_bf16 v[48:63], v[104:107], v[16:23], v5
  ds_read_b128 v[128:131], v230 offset:16384
  ds_read_b64_tr_b16 v[132:133], v9 offset:20480
  ds_read_b64_tr_b16 v[134:135], v9 offset:20992
  v_smfmac_f32_32x32x32_bf16 v[48:63], v[108:111], v[24:31], v5
  ds_read_b128 v[176:179], v231 offset:16384
  ds_read_b64_tr_b16 v[180:181], v9 offset:22528
  ds_read_b64_tr_b16 v[182:183], v9 offset:23040
  v_smfmac_f32_32x32x32_bf16 v[64:79], v[108:111], v[40:47], v5
  ds_read_b128 v[184:187], v227 offset:16384
  ds_read_b64_tr_b16 v[188:189], v8 offset:30720
  ds_read_b64_tr_b16 v[190:191], v8 offset:31232
  v_smfmac_f32_32x32x32_bf16 v[64:79], v[104:107], v[32:39], v5
  s_mov_b64 exec, s[52:53]
  ds_read_b128 v[96:99], v7 offset:0
  ds_read_b128 v[100:103], v7 offset:512
  s_mov_b64 exec, -1
  s_add_u32 m0, s57, 16384
  s_mov_b32 s58, 81920
  buffer_load_dwordx4 v14, s[44:47], s58 offen sc1 lds
  v_mfma_f32_32x32x16_bf16 v[16:31], v[88:91], v[80:83], 0
  ds_read_b128 v[92:95], v6 offset:4096
  s_add_u32 m0, s57, 147456
  s_mov_b32 s58, 1376256
  buffer_load_dwordx4 v12, s[28:31], s58 offen lds
  v_mfma_f32_32x32x16_bf16 v[32:47], v[88:91], v[84:87], 0
  s_add_u32 m0, s57, 155648
  s_mov_b32 s58, 1376256
  buffer_load_dwordx4 v11, s[28:31], s58 offen lds
  s_waitcnt lgkmcnt(3)
  v_mfma_f32_32x32x16_bf16 v[112:127], v[128:131], v[132:135], v[112:127]
  v_mfma_f32_32x32x16_bf16 v[112:127], v[176:179], v[180:183], v[112:127]
  v_mfma_f32_32x32x16_bf16 v[208:223], v[188:191], v[184:187], v[208:223]
  s_waitcnt vmcnt(5)
  s_barrier
  v_exp_f32 v16, v16
  v_exp_f32 v17, v17
  v_exp_f32 v18, v18
L_pad4:
  s_cbranch_execz L_padret
  s_setprio 2
  v_exp_f32 v19, v19
  v_exp_f32 v20, v20
  v_exp_f32 v21, v21
  v_exp_f32 v22, v22
  v_exp_f32 v23, v23
  v_exp_f32 v24, v24
  v_exp_f32 v25, v25
  v_exp_f32 v26, v26
  v_exp_f32 v27, v27
  v_exp_f32 v28, v28
  v_exp_f32 v29, v29
  v_exp_f32 v30, v30
  v_exp_f32 v31, v31
  v_exp_f32 v32, v32
  v_exp_f32 v33, v33
  v_exp_f32 v34, v34
  v_exp_f32 v35, v35
  v_exp_f32 v36, v36
  v_exp_f32 v37, v37
  v_exp_f32 v38, v38
  v_exp_f32 v39, v39
  v_exp_f32 v40, v40
  v_exp_f32 v41, v41
  v_exp_f32 v42, v42
  v_exp_f32 v43, v43
  v_exp_f32 v44, v44
  v_exp_f32 v45, v45
  v_exp_f32 v46, v46
  v_exp_f32 v47, v47
  s_setprio 3
  s_waitcnt lgkmcnt(0)
  v_smfmac_f32_32x32x32_bf16 v[48:63], v[96:99], v[16:23], v5
  ds_read_b128 v[128:131], v228 offset:32768
  ds_read_b64_tr_b16 v[132:133], v9 offset:32768
  ds_read_b64_tr_b16 v[134:135], v9 offset:33280
  v_smfmac_f32_32x32x32_bf16 v[48:63], v[100:103], v[24:31], v5
  ds_read_b128 v[176:179], v229 offset:32768
  ds_read_b64_tr_b16 v[180:181], v9 offset:34816
  ds_read_b64_tr_b16 v[182:183], v9 offset:35328
  v_smfmac_f32_32x32x32_bf16 v[64:79], v[100:103], v[40:47], v5
  ds_read_b128 v[184:187], v226 offset:32768
  ds_read_b64_tr_b16 v[188:189], v8 offset:45056
  ds_read_b64_tr_b16 v[190:191], v8 offset:45568
  v_smfmac_f32_32x32x32_bf16 v[64:79], v[96:99], v[32:39], v5
  s_mov_b64 exec, s[52:53]
  ds_read_b128 v[104:107], v7 offset:4096
  ds_read_b128 v[108:111], v7 offset:4608
  s_mov_b64 exec, -1
  v_mfma_f32_32x32x16_bf16 v[16:31], v[92:95], v[80:83], 0
  ds_read_b128 v[88:91], v6 offset:8192
  s_add_u32 m0, s57, 98304
  s_mov_b32 s58, 0
  buffer_load_dwordx4 v13, s[20:23], s58 offen lds
  v_mfma_f32_32x32x16_bf16 v[32:47], v[92:95], v[84:87], 0
  s_add_u32 m0, s57, 106496
  s_mov_b32 s58, 65536
  buffer_load_dwordx4 v13, s[20:23], s58 offen lds
  s_waitcnt lgkmcnt(3)
  v_mfma_f32_32x32x16_bf16 v[112:127], v[128:131], v[132:135], v[112:127]
  v_mfma_f32_32x32x16_bf16 v[112:127], v[176:179], v[180:183], v[112:127]
  v_mfma_f32_32x32x16_bf16 v[208:223], v[188:191], v[184:187], v[208:223]
  s_setprio 0
  v_exp_f32 v16, v16
  s_setprio 2
  v_exp_f32 v17, v17
  v_exp_f32 v18, v18
  v_exp_f32 v19, v19
  v_exp_f32 v20, v20
  v_exp_f32 v21, v21
  v_exp_f32 v22, v22
  v_exp_f32 v23, v23
  v_exp_f32 v24, v24
  v_exp_f32 v25, v25
  v_exp_f32 v26, v26
  v_exp_f32 v27, v27
  v_exp_f32 v28, v28
  v_exp_f32 v29, v29
  v_exp_f32 v30, v30
  v_exp_f32 v31, v31
  v_exp_f32 v32, v32
  v_exp_f32 v33, v33
  v_exp_f32 v34, v34
  v_exp_f32 v35, v35
  v_exp_f32 v36, v36
  v_exp_f32 v37, v37
  v_exp_f32 v38, v38
  v_exp_f32 v39, v39
  v_exp_f32 v40, v40
  v_exp_f32 v41, v41
  v_exp_f32 v42, v42
  v_exp_f32 v43, v43
  v_exp_f32 v44, v44
  v_exp_f32 v45, v45
  v_exp_f32 v46, v46
  v_exp_f32 v47, v47
  s_setprio 3
  s_waitcnt lgkmcnt(0)
  v_smfmac_f32_32x32x32_bf16 v[48:63], v[104:107], v[16:23], v5
  ds_read_b128 v[128:131], v230 offset:32768
  ds_read_b64_tr_b16 v[132:133], v9 offset:36864
  ds_read_b64_tr_b16 v[134:135], v9 offset:37376
  v_smfmac_f32_32x32x32_bf16 v[48:63], v[108:111], v[24:31], v5
  ds_read_b128 v[176:179], v231 offset:32768
  ds_read_b64_tr_b16 v[180:181], v9 offset:38912
  ds_read_b64_tr_b16 v[182:183], v9 offset:39424
  v_smfmac_f32_32x32x32_bf16 v[64:79], v[108:111], v[40:47], v5
  ds_read_b128 v[184:187], v227 offset:32768
  ds_read_b64_tr_b16 v[188:189], v8 offset:47104
  ds_read_b64_tr_b16 v[190:191], v8 offset:47616
  v_smfmac_f32_32x32x32_bf16 v[64:79], v[104:107], v[32:39], v5
  s_mov_b64 exec, s[52:53]
  ds_read_b128 v[96:99], v7 offset:8192
  ds_read_b128 v[100:103], v7 offset:8704
  s_mov_b64 exec, -1
  s_add_u32 m0, s57, 24576
  s_mov_b32 s58, 90112
  buffer_load_dwordx4 v14, s[44:47], s58 offen sc1 lds
  v_mfma_f32_32x32x16_bf16 v[16:31], v[88:91], v[80:83], 0
  ds_read_b128 v[92:95], v6 offset:12288
  s_add_u32 m0, s57, 32768
  s_mov_b32 s58, 0
  buffer_load_dwordx4 v13, s[32:35], s58 offen lds
  v_mfma_f32_32x32x16_bf16 v[32:47], v[88:91], v[84:87], 0
  s_add_u32 m0, s57, 40960
  s_mov_b32 s58, 65536
  buffer_load_dwordx4 v13, s[32:35], s58 offen lds
  s_waitcnt lgkmcnt(3)
  v_mfma_f32_32x32x16_bf16 v[112:127], v[128:131], v[132:135], v[112:127]
  v_mfma_f32_32x32x16_bf16 v[112:127], v[176:179], v[180:183], v[112:127]
  v_mfma_f32_32x32x16_bf16 v[208:223], v[188:191], v[184:187], v[208:223]
  s_waitcnt vmcnt(5)
  s_barrier
  v_exp_f32 v16, v16
  v_exp_f32 v17, v17
  v_exp_f32 v18, v18
  v_exp_f32 v19, v19
  v_exp_f32 v20, v20
  v_exp_f32 v21, v21
  v_exp_f32 v22, v22
  v_exp_f32 v23, v23
  v_exp_f32 v24, v24
  v_exp_f32 v25, v25
  v_exp_f32 v26, v26
  v_exp_f32 v27, v27
  v_exp_f32 v28, v28
  v_exp_f32 v29, v29
  v_exp_f32 v30, v30
  v_exp_f32 v31, v31
  v_exp_f32 v32, v32
  v_exp_f32 v33, v33
  v_exp_f32 v34, v34
  v_exp_f32 v35, v35
  v_exp_f32 v36, v36
  v_exp_f32 v37, v37
  v_exp_f32 v38, v38
  v_exp_f32 v39, v39
  v_exp_f32 v40, v40
  v_exp_f32 v41, v41
  v_exp_f32 v42, v42
  v_exp_f32 v43, v43
  v_exp_f32 v44, v44
  v_exp_f32 v45, v45
  v_exp_f32 v46, v46
  v_exp_f32 v47, v47
  s_setprio 3
  s_waitcnt lgkmcnt(0)
  v_smfmac_f32_32x32x32_bf16 v[48:63], v[96:99], v[16:23], v5
  ds_read_b128 v[128:131], v228 offset:49152
  ds_read_b64_tr_b16 v[132:133], v9 offset:49152
  ds_read_b64_tr_b16 v[134:135], v9 offset:49664
  v_smfmac_f32_32x32x32_bf16 v[48:63], v[100:103], v[24:31], v5
  ds_read_b128 v[176:179], v229 offset:49152
  ds_read_b64_tr_b16 v[180:181], v9 offset:51200
  ds_read_b64_tr_b16 v[182:183], v9 offset:51712
  v_smfmac_f32_32x32x32_bf16 v[64:79], v[100:103], v[40:47], v5
  ds_read_b128 v[184:187], v226 offset:49152
  ds_read_b64_tr_b16 v[188:189], v8 offset:61440
  ds_read_b64_tr_b16 v[190:191], v8 offset:61952
  v_smfmac_f32_32x32x32_bf16 v[64:79], v[96:99], v[32:39], v5
  s_mov_b64 exec, s[52:53]
  ds_read_b128 v[104:107], v7 offset:12288
  ds_read_b128 v[108:111], v7 offset:12800
  s_mov_b64 exec, -1
  v_mfma_f32_32x32x16_bf16 v[16:31], v[92:95], v[80:83], 0
  ds_read_b128 v[88:91], v6 offset:16384
  s_add_u32 m0, s57, 114688
  s_mov_b32 s58, 131072
  buffer_load_dwordx4 v13, s[20:23], s58 offen lds
  v_mfma_f32_32x32x16_bf16 v[32:47], v[92:95], v[84:87], 0
  s_add_u32 m0, s57, 122880
  s_mov_b32 s58, 196608
  buffer_load_dwordx4 v13, s[20:23], s58 offen lds
  s_waitcnt lgkmcnt(3)
  v_mfma_f32_32x32x16_bf16 v[112:127], v[128:131], v[132:135], v[112:127]
  v_mfma_f32_32x32x16_bf16 v[112:127], v[176:179], v[180:183], v[112:127]
  v_mfma_f32_32x32x16_bf16 v[208:223], v[188:191], v[184:187], v[208:223]
  s_setprio 0
  v_exp_f32 v16, v16
  s_setprio 2
  v_exp_f32 v17, v17
  v_exp_f32 v18, v18
  v_exp_f32 v19, v19
  v_exp_f32 v20, v20
  v_exp_f32 v21, v21
  v_exp_f32 v22, v22
  v_exp_f32 v23, v23
  v_exp_f32 v24, v24
  v_exp_f32 v25, v25
  v_exp_f32 v26, v26
  v_exp_f32 v27, v27
  v_exp_f32 v28, v28
  v_exp_f32 v29, v29
  v_exp_f32 v30, v30
  v_exp_f32 v31, v31
  v_exp_f32 v32, v32
  v_exp_f32 v33, v33
  v_exp_f32 v34, v34
  v_exp_f32 v35, v35
  v_exp_f32 v36, v36
  v_exp_f32 v37, v37
  v_exp_f32 v38, v38
  v_exp_f32 v39, v39
  v_exp_f32 v40, v40
  v_exp_f32 v41, v41
  v_exp_f32 v42, v42
  v_exp_f32 v43, v43
  v_exp_f32 v44, v44
  v_exp_f32 v45, v45
  v_exp_f32 v46, v46
  v_exp_f32 v47, v47
  s_setprio 3
  s_waitcnt lgkmcnt(0)
  v_smfmac_f32_32x32x32_bf16 v[48:63], v[104:107], v[16:23], v5
  ds_read_b128 v[128:131], v230 offset:49152
  ds_read_b64_tr_b16 v[132:133], v9 offset:53248
  ds_read_b64_tr_b16 v[134:135], v9 offset:53760
  v_smfmac_f32_32x32x32_bf16 v[48:63], v[108:111], v[24:31], v5
  ds_read_b128 v[176:179], v231 offset:49152
  ds_read_b64_tr_b16 v[180:181], v9 offset:55296
  ds_read_b64_tr_b16 v[182:183], v9 offset:55808
  v_smfmac_f32_32x32x32_bf16 v[64:79], v[108:111], v[40:47], v5
  ds_read_b128 v[184:187], v227 offset:49152
  ds_read_b64_tr_b16 v[188:189], v8 offset:63488
  ds_read_b64_tr_b16 v[190:191], v8 offset:64000
  v_smfmac_f32_32x32x32_bf16 v[64:79], v[104:107], v[32:39], v5
  s_mov_b64 exec, s[52:53]
  ds_read_b128 v[96:99], v7 offset:16384
  ds_read_b128 v[100:103], v7 offset:16896
  s_mov_b64 exec, -1
  v_mfma_f32_32x32x16_bf16 v[16:31], v[88:91], v[80:83], 0
  ds_read_b128 v[92:95], v6 offset:20480
  v_mfma_f32_32x32x16_bf16 v[32:47], v[88:91], v[84:87], 0
  s_waitcnt lgkmcnt(3)
  v_mfma_f32_32x32x16_bf16 v[112:127], v[128:131], v[132:135], v[112:127]
  v_mfma_f32_32x32x16_bf16 v[112:127], v[176:179], v[180:183], v[112:127]
  v_mfma_f32_32x32x16_bf16 v[208:223], v[188:191], v[184:187], v[208:223]
  s_nop 10
  v_cvt_pk_bf16_f32 v112, v112, v113
  v_cvt_pk_bf16_f32 v113, v114, v115
  v_cvt_pk_bf16_f32 v114, v116, v117
  v_cvt_pk_bf16_f32 v115, v118, v119
  v_cvt_pk_bf16_f32 v116, v120, v121
  v_cvt_pk_bf16_f32 v117, v122, v123
  v_cvt_pk_bf16_f32 v118, v124, v125
  v_cvt_pk_bf16_f32 v119, v126, v127
  ds_write_b128 v240, v[112:115] offset:16384
  ds_write_b128 v240, v[116:119] offset:17408
  ds_write_b128 v240, v[208:211]
  ds_write_b128 v240, v[212:215] offset:1024
  s_setprio 0
  v_exp_f32 v16, v16
  s_setprio 2
  v_exp_f32 v17, v17
  v_exp_f32 v18, v18
  v_exp_f32 v19, v19
  v_exp_f32 v20, v20
  v_exp_f32 v21, v21
  v_exp_f32 v22, v22
  v_exp_f32 v23, v23
  v_exp_f32 v24, v24
  s_waitcnt vmcnt(4)
  s_waitcnt lgkmcnt(0)
  s_barrier
  v_exp_f32 v25, v25
  v_exp_f32 v26, v26
  v_exp_f32 v27, v27
  ds_read_b128 v[208:211], v241
  ds_read_b128 v[212:215], v241 offset:1024
  v_exp_f32 v28, v28
  v_exp_f32 v29, v29
  v_exp_f32 v30, v30
  v_exp_f32 v31, v31
  v_exp_f32 v32, v32
  v_exp_f32 v33, v33
  v_exp_f32 v34, v34
  v_exp_f32 v35, v35
  v_exp_f32 v36, v36
  v_exp_f32 v37, v37
  v_exp_f32 v38, v38
  v_exp_f32 v39, v39
  v_exp_f32 v40, v40
  v_exp_f32 v41, v41
  v_exp_f32 v42, v42
  v_exp_f32 v43, v43
  v_exp_f32 v44, v44
  v_exp_f32 v45, v45
  v_exp_f32 v46, v46
  v_exp_f32 v47, v47
  s_waitcnt lgkmcnt(1)
  v_pk_add_f32 v[216:217], v[216:217], v[208:209]
  v_pk_add_f32 v[218:219], v[218:219], v[210:211]
  s_waitcnt lgkmcnt(0)
  v_pk_add_f32 v[220:221], v[220:221], v[212:213]
  v_pk_add_f32 v[222:223], v[222:223], v[214:215]
  v_pk_mul_f32 v[248:249], v[216:217], s[12:13]
  v_pk_mul_f32 v[250:251], v[218:219], s[12:13]
  v_max_f32 v216, 0, v216
  v_max_f32 v217, 0, v217
  v_max_f32 v218, 0, v218
  v_max_f32 v219, 0, v219
  v_exp_f32_e64 v248, v248 clamp
  v_exp_f32_e64 v249, v249 clamp
  v_exp_f32_e64 v250, v250 clamp
  v_exp_f32_e64 v251, v251 clamp
  v_pk_add_f32 v[216:217], v[216:217], s[16:17]
  v_pk_add_f32 v[218:219], v[218:219], s[16:17]
  v_pk_add_f32 v[216:217], v[216:217], v[248:249]
  v_pk_add_f32 v[218:219], v[218:219], v[250:251]
  v_pk_mul_f32 v[248:249], v[220:221], s[12:13]
  v_pk_mul_f32 v[250:251], v[222:223], s[12:13]
  v_max_f32 v220, 0, v220
  v_max_f32 v221, 0, v221
  v_max_f32 v222, 0, v222
  v_max_f32 v223, 0, v223
  v_exp_f32_e64 v248, v248 clamp
  v_exp_f32_e64 v249, v249 clamp
  v_exp_f32_e64 v250, v250 clamp
  v_exp_f32_e64 v251, v251 clamp
  v_pk_add_f32 v[220:221], v[220:221], s[16:17]
  v_pk_add_f32 v[222:223], v[222:223], s[16:17]
  v_pk_add_f32 v[220:221], v[220:221], v[248:249]
  v_pk_add_f32 v[222:223], v[222:223], v[250:251]
  v_cvt_pk_bf16_f32 v136, v216, v217
  v_cvt_pk_bf16_f32 v137, v218, v219
  v_cvt_pk_bf16_f32 v138, v220, v221
  v_cvt_pk_bf16_f32 v139, v222, v223
  s_setprio 3
  v_smfmac_f32_32x32x32_bf16 v[48:63], v[96:99], v[16:23], v5
  v_smfmac_f32_32x32x32_bf16 v[48:63], v[100:103], v[24:31], v5
  v_smfmac_f32_32x32x32_bf16 v[64:79], v[100:103], v[40:47], v5
  v_smfmac_f32_32x32x32_bf16 v[64:79], v[96:99], v[32:39], v5
  s_mov_b64 exec, s[52:53]
  ds_read_b128 v[104:107], v7 offset:20480
  ds_read_b128 v[108:111], v7 offset:20992
  s_mov_b64 exec, -1
  s_add_u32 m0, s57, 0
  s_mov_b32 s58, 98304
  buffer_load_dwordx4 v14, s[44:47], s58 offen sc1 lds
  v_mfma_f32_32x32x16_bf16 v[16:31], v[92:95], v[80:83], 0
  ds_read_b128 v[88:91], v6 offset:24576
  s_add_u32 m0, s57, 131072
  s_mov_b32 s58, 262144
  buffer_load_dwordx4 v13, s[20:23], s58 offen lds
  v_mfma_f32_32x32x16_bf16 v[32:47], v[92:95], v[84:87], 0
  s_add_u32 m0, s57, 139264
  s_mov_b32 s58, 327680
  buffer_load_dwordx4 v13, s[20:23], s58 offen lds
  s_nop 9
  s_setprio 0
  v_exp_f32 v16, v16
  s_setprio 2
  v_exp_f32 v17, v17
  v_exp_f32 v18, v18
  v_exp_f32 v19, v19
  v_exp_f32 v20, v20
  v_exp_f32 v21, v21
  v_exp_f32 v22, v22
  v_exp_f32 v23, v23
  v_exp_f32 v24, v24
  v_exp_f32 v25, v25
  v_exp_f32 v26, v26
  v_exp_f32 v27, v27
  v_exp_f32 v28, v28
  v_exp_f32 v29, v29
  v_exp_f32 v30, v30
  v_exp_f32 v31, v31
  v_exp_f32 v32, v32
  v_exp_f32 v33, v33
  v_exp_f32 v34, v34
  v_exp_f32 v35, v35
  v_exp_f32 v36, v36
  v_exp_f32 v37, v37
  v_exp_f32 v38, v38
  v_exp_f32 v39, v39
  v_exp_f32 v40, v40
  v_exp_f32 v41, v41
  v_exp_f32 v42, v42
  v_exp_f32 v43, v43
  v_exp_f32 v44, v44
  v_exp_f32 v45, v45
  v_exp_f32 v46, v46
  v_exp_f32 v47, v47
  s_setprio 3
  s_waitcnt lgkmcnt(0)
  v_smfmac_f32_32x32x32_bf16 v[48:63], v[104:107], v[16:23], v5
  v_smfmac_f32_32x32x32_bf16 v[48:63], v[108:111], v[24:31], v5
  v_smfmac_f32_32x32x32_bf16 v[64:79], v[108:111], v[40:47], v5
  v_smfmac_f32_32x32x32_bf16 v[64:79], v[104:107], v[32:39], v5
  s_mov_b64 exec, s[52:53]
  ds_read_b128 v[96:99], v7 offset:24576
  ds_read_b128 v[100:103], v7 offset:25088
  s_mov_b64 exec, -1
  s_add_u32 m0, s57, 8192
  s_mov_b32 s58, 106496
  buffer_load_dwordx4 v14, s[44:47], s58 offen sc1 lds
  v_mfma_f32_32x32x16_bf16 v[16:31], v[88:91], v[80:83], 0
  ds_read_b128 v[92:95], v6 offset:28672
  s_add_u32 m0, s57, 147456
  s_mov_b32 s58, 393216
  buffer_load_dwordx4 v13, s[20:23], s58 offen lds
  v_mfma_f32_32x32x16_bf16 v[32:47], v[88:91], v[84:87], 0
  s_add_u32 m0, s57, 155648
  s_mov_b32 s58, 458752
  buffer_load_dwordx4 v13, s[20:23], s58 offen lds
  s_nop 9
  s_waitcnt vmcnt(5)
  s_barrier
  v_exp_f32 v16, v16
  v_exp_f32 v17, v17
  v_exp_f32 v18, v18
  v_exp_f32 v19, v19
  v_exp_f32 v20, v20
  v_exp_f32 v21, v21
  v_exp_f32 v22, v22
  v_exp_f32 v23, v23
  v_exp_f32 v24, v24
  v_exp_f32 v25, v25
  v_exp_f32 v26, v26
  v_exp_f32 v27, v27
  v_exp_f32 v28, v28
  v_exp_f32 v29, v29
  v_exp_f32 v30, v30
  v_exp_f32 v31, v31
  v_exp_f32 v32, v32
  v_exp_f32 v33, v33
  v_exp_f32 v34, v34
  v_exp_f32 v35, v35
  v_exp_f32 v36, v36
  v_exp_f32 v37, v37
  v_exp_f32 v38, v38
  v_exp_f32 v39, v39
  v_exp_f32 v40, v40
  v_exp_f32 v41, v41
  v_exp_f32 v42, v42
  v_exp_f32 v43, v43
  v_exp_f32 v44, v44
  v_exp_f32 v45, v45
  v_exp_f32 v46, v46
  v_exp_f32 v47, v47
  s_setprio 3
  s_waitcnt lgkmcnt(0)
  v_smfmac_f32_32x32x32_bf16 v[48:63], v[96:99], v[16:23], v5
  v_smfmac_f32_32x32x32_bf16 v[48:63], v[100:103], v[24:31], v5
  buffer_load_dwordx4 v[144:147], v2, s[44:47], s73 offen sc1
  v_smfmac_f32_32x32x32_bf16 v[64:79], v[100:103], v[40:47], v5
  buffer_load_dwordx4 v[148:151], v2, s[44:47], s73 offen offset:1024 sc1
  v_smfmac_f32_32x32x32_bf16 v[64:79], v[96:99], v[32:39], v5
  s_mov_b64 exec, s[52:53]
  ds_read_b128 v[104:107], v7 offset:28672
  ds_read_b128 v[108:111], v7 offset:29184
  s_mov_b64 exec, -1
  v_mfma_f32_32x32x16_bf16 v[16:31], v[92:95], v[80:83], 0
  ds_read_b128 v[88:91], v6 offset:0
  buffer_load_dwordx4 v[152:155], v2, s[44:47], s73 offen offset:2048 sc1
  v_mfma_f32_32x32x16_bf16 v[32:47], v[92:95], v[84:87], 0
  buffer_load_dwordx4 v[156:159], v2, s[44:47], s73 offen offset:3072 sc1
  s_nop 9
  s_setprio 0
  v_exp_f32 v16, v16
  s_setprio 2
  v_exp_f32 v17, v17
  v_exp_f32 v18, v18
  v_exp_f32 v19, v19
  v_exp_f32 v20, v20
  v_exp_f32 v21, v21
  v_exp_f32 v22, v22
  v_exp_f32 v23, v23
  v_exp_f32 v24, v24
  v_exp_f32 v25, v25
  v_exp_f32 v26, v26
  v_exp_f32 v27, v27
  v_exp_f32 v28, v28
  v_exp_f32 v29, v29
  v_exp_f32 v30, v30
  v_exp_f32 v31, v31
  v_exp_f32 v32, v32
  v_exp_f32 v33, v33
  v_exp_f32 v34, v34
  v_exp_f32 v35, v35
  v_exp_f32 v36, v36
  v_exp_f32 v37, v37
  v_exp_f32 v38, v38
  v_exp_f32 v39, v39
  v_exp_f32 v40, v40
  v_exp_f32 v41, v41
  v_exp_f32 v42, v42
  v_exp_f32 v43, v43
  v_exp_f32 v44, v44
  v_exp_f32 v45, v45
  v_exp_f32 v46, v46
  v_exp_f32 v47, v47
  s_setprio 3
  s_waitcnt lgkmcnt(0)
  v_smfmac_f32_32x32x32_bf16 v[48:63], v[104:107], v[16:23], v5
  v_smfmac_f32_32x32x32_bf16 v[48:63], v[108:111], v[24:31], v5
  v_smfmac_f32_32x32x32_bf16 v[64:79], v[108:111], v[40:47], v5
  v_smfmac_f32_32x32x32_bf16 v[64:79], v[104:107], v[32:39], v5
  s_mov_b64 exec, s[52:53]
  ds_read_b128 v[96:99], v7 offset:0
  ds_read_b128 v[100:103], v7 offset:512
  s_mov_b64 exec, -1
  s_add_u32 m0, s57, 16384
  s_mov_b32 s58, 114688
  buffer_load_dwordx4 v14, s[44:47], s58 offen sc1 lds
  v_mfma_f32_32x32x16_bf16 v[16:31], v[88:91], v[80:83], 0
  ds_read_b128 v[92:95], v6 offset:4096
  s_add_u32 m0, s57, 81920
  s_mov_b32 s58, 393216
  buffer_load_dwordx4 v13, s[32:35], s58 offen lds
  v_mfma_f32_32x32x16_bf16 v[32:47], v[88:91], v[84:87], 0
  s_add_u32 m0, s57, 90112
  s_mov_b32 s58, 458752
  buffer_load_dwordx4 v13, s[32:35], s58 offen lds
  s_nop 9
  s_waitcnt vmcnt(9)
  s_barrier
  v_exp_f32 v16, v16
  v_exp_f32 v17, v17
  v_exp_f32 v18, v18
  v_exp_f32 v19, v19
  v_exp_f32 v20, v20
  v_exp_f32 v21, v21
  v_exp_f32 v22, v22
  v_exp_f32 v23, v23
  v_exp_f32 v24, v24
  v_exp_f32 v25, v25
  v_exp_f32 v26, v26
  v_exp_f32 v27, v27
  v_exp_f32 v28, v28
  v_exp_f32 v29, v29
  v_exp_f32 v30, v30
  v_exp_f32 v31, v31
  v_exp_f32 v32, v32
  v_exp_f32 v33, v33
  v_exp_f32 v34, v34
  v_exp_f32 v35, v35
  v_exp_f32 v36, v36
  v_exp_f32 v37, v37
  v_exp_f32 v38, v38
  v_exp_f32 v39, v39
  v_exp_f32 v40, v40
  v_exp_f32 v41, v41
  v_exp_f32 v42, v42
  v_exp_f32 v43, v43
  v_exp_f32 v44, v44
  v_exp_f32 v45, v45
  v_exp_f32 v46, v46
  v_exp_f32 v47, v47
  s_waitcnt vmcnt(3)
  v_max3_u32 v15, v144, v148, v152
  v_max_u32 v15, v15, v156
  v_cmp_eq_u32 vcc, -1, v15
  s_setprio 3
  s_waitcnt lgkmcnt(0)
  v_smfmac_f32_32x32x32_bf16 v[48:63], v[96:99], v[16:23], v5
  s_cbranch_vccnz L_slow_pm1_0
L_back_pm1_0:
  v_smfmac_f32_32x32x32_bf16 v[48:63], v[100:103], v[24:31], v5
  v_smfmac_f32_32x32x32_bf16 v[64:79], v[100:103], v[40:47], v5
  v_smfmac_f32_32x32x32_bf16 v[64:79], v[96:99], v[32:39], v5
  s_mov_b64 exec, s[52:53]
  ds_read_b128 v[104:107], v7 offset:4096
  ds_read_b128 v[108:111], v7 offset:4608
  s_mov_b64 exec, -1
  v_mfma_f32_32x32x16_bf16 v[16:31], v[92:95], v[80:83], 0
  ds_read_b128 v[88:91], v6 offset:8192
  s_add_u32 m0, s57, 49152
  s_mov_b32 s58, 131072
  buffer_load_dwordx4 v13, s[32:35], s58 offen lds
  v_mfma_f32_32x32x16_bf16 v[32:47], v[92:95], v[84:87], 0
  s_add_u32 m0, s57, 57344
  s_mov_b32 s58, 196608
  buffer_load_dwordx4 v13, s[32:35], s58 offen lds
  v_mfma_f32_32x32x16_bf16 v[112:127], v[192:195], v[144:147], 0
  v_mfma_f32_32x32x16_bf16 v[112:127], v[192:195], v[148:151], v[112:127]
  v_mfma_f32_32x32x16_bf16 v[112:127], v[192:195], v[152:155], v[112:127]
  v_mfma_f32_32x32x16_bf16 v[112:127], v[192:195], v[156:159], v[112:127]
  s_setprio 0
  v_exp_f32 v16, v16
  s_setprio 2
  v_exp_f32 v17, v17
  v_exp_f32 v18, v18
  v_exp_f32 v19, v19
  v_exp_f32 v20, v20
  v_exp_f32 v21, v21
  v_exp_f32 v22, v22
  v_exp_f32 v23, v23
  v_exp_f32 v24, v24
  v_exp_f32 v25, v25
  v_exp_f32 v26, v26
  v_exp_f32 v27, v27
  v_cvt_pk_bf16_f32 v112, v112, v113
  v_cvt_pk_bf16_f32 v113, v114, v115
  v_cvt_pk_bf16_f32 v114, v116, v117
  v_cvt_pk_bf16_f32 v115, v118, v119
  v_min_u32 v112, -2, v112
  s_cmp_lg_u32 s72, 0
  s_cbranch_scc1 L_far_p2
  buffer_store_dwordx4 v[112:115], v2, s[44:47], s50 offen
L_near_p2:
  v_exp_f32 v28, v28
  v_exp_f32 v29, v29
  v_exp_f32 v30, v30
  v_exp_f32 v31, v31
  v_exp_f32 v32, v32
  v_exp_f32 v33, v33
  v_exp_f32 v34, v34
  v_exp_f32 v35, v35
  v_exp_f32 v36, v36
  v_exp_f32 v37, v37
  v_exp_f32 v38, v38
  v_exp_f32 v39, v39
  v_exp_f32 v40, v40
  v_exp_f32 v41, v41
  v_exp_f32 v42, v42
  v_exp_f32 v43, v43
  v_exp_f32 v44, v44
  v_exp_f32 v45, v45
  v_exp_f32 v46, v46
  v_exp_f32 v47, v47
  s_setprio 3
  s_waitcnt lgkmcnt(0)
  v_smfmac_f32_32x32x32_bf16 v[48:63], v[104:107], v[16:23], v5
  v_smfmac_f32_32x32x32_bf16 v[48:63], v[108:111], v[24:31], v5
  v_smfmac_f32_32x32x32_bf16 v[64:79], v[108:111], v[40:47], v5
  v_smfmac_f32_32x32x32_bf16 v[64:79], v[104:107], v[32:39], v5
  s_mov_b64 exec, s[52:53]
  ds_read_b128 v[96:99], v7 offset:8192
  ds_read_b128 v[100:103], v7 offset:8704
  s_mov_b64 exec, -1
  s_add_u32 m0, s57, 24576
  s_mov_b32 s58, 122880
  buffer_load_dwordx4 v14, s[44:47], s58 offen sc1 lds
  v_mfma_f32_32x32x16_bf16 v[16:31], v[88:91], v[80:83], 0
  ds_read_b128 v[92:95], v6 offset:12288
  s_add_u32 m0, s57, 65536
  s_mov_b32 s58, 262144
  buffer_load_dwordx4 v13, s[32:35], s58 offen lds
  v_mfma_f32_32x32x16_bf16 v[32:47], v[88:91], v[84:87], 0
  s_add_u32 m0, s57, 73728
  s_mov_b32 s58, 327680
  buffer_load_dwordx4 v13, s[32:35], s58 offen lds
  s_nop 9
  s_waitcnt vmcnt(8)
  s_barrier
  v_exp_f32 v16, v16
  v_exp_f32 v17, v17
  v_exp_f32 v18, v18
  v_exp_f32 v19, v19
  v_exp_f32 v20, v20
  v_exp_f32 v21, v21
  v_exp_f32 v22, v22
  v_exp_f32 v23, v23
  v_exp_f32 v24, v24
  v_exp_f32 v25, v25
  v_exp_f32 v26, v26
  v_exp_f32 v27, v27
  v_exp_f32 v28, v28
  v_exp_f32 v29, v29
  v_exp_f32 v30, v30
  v_exp_f32 v31, v31
  v_exp_f32 v32, v32
  v_exp_f32 v33, v33
  v_exp_f32 v34, v34
  v_exp_f32 v35, v35
  v_exp_f32 v36, v36
  v_exp_f32 v37, v37
  v_exp_f32 v38, v38
  v_exp_f32 v39, v39
  v_exp_f32 v40, v40
  v_exp_f32 v41, v41
  v_exp_f32 v42, v42
  v_exp_f32 v43, v43
  v_exp_f32 v44, v44
  v_exp_f32 v45, v45
  v_exp_f32 v46, v46
  v_exp_f32 v47, v47
  s_setprio 3
  s_waitcnt lgkmcnt(0)
  v_smfmac_f32_32x32x32_bf16 v[48:63], v[96:99], v[16:23], v5
  buffer_load_dwordx4 v[160:163], v2, s[44:47], s75 offen sc1
  v_smfmac_f32_32x32x32_bf16 v[48:63], v[100:103], v[24:31], v5
  buffer_load_dwordx4 v[164:167], v2, s[44:47], s75 offen offset:1024 sc1
  v_smfmac_f32_32x32x32_bf16 v[64:79], v[100:103], v[40:47], v5
  buffer_load_dwordx4 v[168:171], v2, s[44:47], s75 offen offset:2048 sc1
  v_smfmac_f32_32x32x32_bf16 v[64:79], v[96:99], v[32:39], v5
  s_mov_b64 exec, s[52:53]
  ds_read_b128 v[104:107], v7 offset:12288
  ds_read_b128 v[108:111], v7 offset:12800
  s_mov_b64 exec, -1
  buffer_load_dwordx4 v[172:175], v2, s[44:47], s75 offen offset:3072 sc1
  v_mfma_f32_32x32x16_bf16 v[16:31], v[92:95], v[80:83], 0
  ds_read_b128 v[88:91], v6 offset:16384
  v_mfma_f32_32x32x16_bf16 v[32:47], v[92:95], v[84:87], 0
  s_nop 9
  s_setprio 0
  v_exp_f32 v16, v16
  s_setprio 2
  v_exp_f32 v17, v17
  v_exp_f32 v18, v18
  v_exp_f32 v19, v19
  v_exp_f32 v20, v20
  v_exp_f32 v21, v21
  v_exp_f32 v22, v22
  v_exp_f32 v23, v23
  v_exp_f32 v24, v24
  v_exp_f32 v25, v25
  v_exp_f32 v26, v26
  v_exp_f32 v27, v27
  v_exp_f32 v28, v28
  v_exp_f32 v29, v29
  v_exp_f32 v30, v30
  v_exp_f32 v31, v31
  v_exp_f32 v32, v32
  v_exp_f32 v33, v33
  v_exp_f32 v34, v34
  v_exp_f32 v35, v35
  v_exp_f32 v36, v36
  v_exp_f32 v37, v37
  v_exp_f32 v38, v38
  v_exp_f32 v39, v39
  v_exp_f32 v40, v40
  v_exp_f32 v41, v41
  v_exp_f32 v42, v42
  v_exp_f32 v43, v43
  v_exp_f32 v44, v44
  v_exp_f32 v45, v45
  v_exp_f32 v46, v46
  v_exp_f32 v47, v47
  s_waitcnt vmcnt(0)
  v_max3_u32 v15, v160, v164, v168
  v_max_u32 v15, v15, v172
  v_cmp_eq_u32 vcc, -1, v15
  s_setprio 3
  s_waitcnt lgkmcnt(0)
  v_smfmac_f32_32x32x32_bf16 v[48:63], v[104:107], v[16:23], v5
L_pad5:
  s_cbranch_execz L_padret
  s_cbranch_vccnz L_slow_pm1_1
L_back_pm1_1:
  v_smfmac_f32_32x32x32_bf16 v[48:63], v[108:111], v[24:31], v5
  v_smfmac_f32_32x32x32_bf16 v[64:79], v[108:111], v[40:47], v5
  v_smfmac_f32_32x32x32_bf16 v[64:79], v[104:107], v[32:39], v5
  s_mov_b64 exec, s[52:53]
  ds_read_b128 v[96:99], v7 offset:16384
  ds_read_b128 v[100:103], v7 offset:16896
  s_mov_b64 exec, -1
  v_mfma_f32_32x32x16_bf16 v[16:31], v[88:91], v[80:83], 0
  ds_read_b128 v[92:95], v6 offset:20480
  v_mfma_f32_32x32x16_bf16 v[32:47], v[88:91], v[84:87], 0
  v_mfma_f32_32x32x16_bf16 v[112:127], v[160:163], v[136:139], 0
  v_mfma_f32_32x32x16_bf16 v[112:127], v[164:167], v[136:139], v[112:127]
  v_mfma_f32_32x32x16_bf16 v[112:127], v[168:171], v[136:139], v[112:127]
  v_mfma_f32_32x32x16_bf16 v[112:127], v[172:175], v[136:139], v[112:127]
  s_barrier
  v_exp_f32 v16, v16
  v_exp_f32 v17, v17
  v_exp_f32 v18, v18
  v_exp_f32 v19, v19
  v_exp_f32 v20, v20
  v_exp_f32 v21, v21
  v_exp_f32 v22, v22
  v_exp_f32 v23, v23
  v_exp_f32 v24, v24
  v_exp_f32 v25, v25
  v_exp_f32 v26, v26
  v_exp_f32 v27, v27
  v_add_f32 v120, 0x358637bd, v120
  v_rcp_f32 v120, v120
  s_nop 0
  v_mul_f32 v112, v112, v120
  v_mul_f32 v113, v113, v120
  v_mul_f32 v114, v114, v120
  v_mul_f32 v115, v115, v120
  v_mul_f32 v116, v116, v120
  v_mul_f32 v117, v117, v120
  v_mul_f32 v118, v118, v120
  v_mul_f32 v119, v119, v120
  v_cvt_pk_bf16_f32 v252, v112, v113
  v_cvt_pk_bf16_f32 v253, v114, v115
  v_cvt_pk_bf16_f32 v254, v116, v117
  v_cvt_pk_bf16_f32 v255, v118, v119
  v_min_u32 v252, -2, v252
  s_mov_b32 s58, 3145728
  s_cmp_lg_u32 s72, 0
  s_cbranch_scc1 L_far_ob1
  buffer_store_dwordx4 v[252:255], v236, s[44:47], s58 offen
L_near_ob1:
  v_exp_f32 v28, v28
  v_exp_f32 v29, v29
  v_exp_f32 v30, v30
  v_exp_f32 v31, v31
  v_exp_f32 v32, v32
  v_exp_f32 v33, v33
  v_exp_f32 v34, v34
  v_exp_f32 v35, v35
  v_exp_f32 v36, v36
  v_exp_f32 v37, v37
  v_exp_f32 v38, v38
  v_exp_f32 v39, v39
  v_exp_f32 v40, v40
  v_exp_f32 v41, v41
  v_exp_f32 v42, v42
  v_exp_f32 v43, v43
  v_exp_f32 v44, v44
  v_exp_f32 v45, v45
  v_exp_f32 v46, v46
  v_exp_f32 v47, v47
  s_setprio 3
  s_waitcnt lgkmcnt(0)
  v_smfmac_f32_32x32x32_bf16 v[48:63], v[96:99], v[16:23], v5
  ds_read_b64_tr_b16 v[112:113], v232 offset:0
  ds_read_b64_tr_b16 v[114:115], v232 offset:1024
  ds_read_b64_tr_b16 v[116:117], v233 offset:0
  ds_read_b64_tr_b16 v[118:119], v233 offset:1024
  ds_read_b64_tr_b16 v[120:121], v234 offset:0
  v_smfmac_f32_32x32x32_bf16 v[48:63], v[100:103], v[24:31], v5
  ds_read_b64_tr_b16 v[122:123], v234 offset:1024
  ds_read_b64_tr_b16 v[124:125], v235 offset:0
  ds_read_b64_tr_b16 v[126:127], v235 offset:1024
  ds_read_b64_tr_b16 v[128:129], v232 offset:4096
  ds_read_b64_tr_b16 v[130:131], v232 offset:5120
  v_smfmac_f32_32x32x32_bf16 v[64:79], v[100:103], v[40:47], v5
  ds_read_b64_tr_b16 v[132:133], v233 offset:4096
  ds_read_b64_tr_b16 v[134:135], v233 offset:5120
  ds_read_b64_tr_b16 v[136:137], v234 offset:4096
  ds_read_b64_tr_b16 v[138:139], v234 offset:5120
  ds_read_b64_tr_b16 v[140:141], v235 offset:4096
  v_smfmac_f32_32x32x32_bf16 v[64:79], v[96:99], v[32:39], v5
  s_mov_b64 exec, s[52:53]
  s_waitcnt lgkmcnt(11)
  ds_read_b128 v[104:107], v7 offset:20480
  ds_read_b128 v[108:111], v7 offset:20992
  s_mov_b64 exec, -1
  ds_read_b64_tr_b16 v[142:143], v235 offset:5120
  ds_read_b64_tr_b16 v[144:145], v232 offset:8192
  s_waitcnt lgkmcnt(11)
  ds_read_b64_tr_b16 v[146:147], v232 offset:9216
  ds_read_b64_tr_b16 v[148:149], v233 offset:8192
  ds_read_b64_tr_b16 v[150:151], v233 offset:9216
  v_mfma_f32_32x32x16_bf16 v[16:31], v[92:95], v[80:83], 0
  ds_read_b128 v[88:91], v6 offset:24576
  s_waitcnt lgkmcnt(11)
  ds_read_b64_tr_b16 v[152:153], v234 offset:8192
  ds_read_b64_tr_b16 v[154:155], v234 offset:9216
  ds_read_b64_tr_b16 v[156:157], v235 offset:8192
  ds_read_b64_tr_b16 v[158:159], v235 offset:9216
  s_waitcnt lgkmcnt(11)
  ds_read_b64_tr_b16 v[160:161], v232 offset:12288
  v_mfma_f32_32x32x16_bf16 v[32:47], v[92:95], v[84:87], 0
  s_nop 9
  s_setprio 0
  v_exp_f32 v16, v16
  s_setprio 2
  v_exp_f32 v17, v17
  v_exp_f32 v18, v18
  v_exp_f32 v19, v19
  v_exp_f32 v20, v20
  v_exp_f32 v21, v21
  v_exp_f32 v22, v22
  v_exp_f32 v23, v23
  v_exp_f32 v24, v24
  v_exp_f32 v25, v25
  v_exp_f32 v26, v26
  v_exp_f32 v27, v27
  v_exp_f32 v28, v28
  v_exp_f32 v29, v29
  v_exp_f32 v30, v30
  v_exp_f32 v31, v31
  v_exp_f32 v32, v32
  v_exp_f32 v33, v33
  v_exp_f32 v34, v34
  v_exp_f32 v35, v35
  v_exp_f32 v36, v36
  v_exp_f32 v37, v37
  v_exp_f32 v38, v38
  v_exp_f32 v39, v39
  v_exp_f32 v40, v40
  v_exp_f32 v41, v41
  v_exp_f32 v42, v42
  v_exp_f32 v43, v43
  v_exp_f32 v44, v44
  v_exp_f32 v45, v45
  v_exp_f32 v46, v46
  v_exp_f32 v47, v47
  s_setprio 3
  s_waitcnt lgkmcnt(0)
  v_smfmac_f32_32x32x32_bf16 v[48:63], v[104:107], v[16:23], v5
  ds_read_b64_tr_b16 v[162:163], v232 offset:13312
  ds_read_b64_tr_b16 v[164:165], v233 offset:12288
  ds_read_b64_tr_b16 v[166:167], v233 offset:13312
  ds_read_b64_tr_b16 v[168:169], v234 offset:12288
  ds_read_b64_tr_b16 v[170:171], v234 offset:13312
  v_smfmac_f32_32x32x32_bf16 v[48:63], v[108:111], v[24:31], v5
  ds_read_b64_tr_b16 v[172:173], v235 offset:12288
  ds_read_b64_tr_b16 v[174:175], v235 offset:13312
  ds_read_b64_tr_b16 v[176:177], v232 offset:16384
  ds_read_b64_tr_b16 v[178:179], v232 offset:17408
  ds_read_b64_tr_b16 v[180:181], v233 offset:16384
  v_smfmac_f32_32x32x32_bf16 v[64:79], v[108:111], v[40:47], v5
  ds_read_b64_tr_b16 v[182:183], v233 offset:17408
  ds_read_b64_tr_b16 v[184:185], v234 offset:16384
  ds_read_b64_tr_b16 v[186:187], v234 offset:17408
  ds_read_b64_tr_b16 v[188:189], v235 offset:16384
  ds_read_b64_tr_b16 v[190:191], v235 offset:17408
  v_smfmac_f32_32x32x32_bf16 v[64:79], v[104:107], v[32:39], v5
  s_mov_b64 exec, s[52:53]
  s_waitcnt lgkmcnt(11)
  ds_read_b128 v[96:99], v7 offset:24576
  ds_read_b128 v[100:103], v7 offset:25088
  s_mov_b64 exec, -1
  ds_read_b64_tr_b16 v[192:193], v232 offset:20480
  ds_read_b64_tr_b16 v[194:195], v232 offset:21504
  s_waitcnt lgkmcnt(11)
  ds_read_b64_tr_b16 v[196:197], v233 offset:20480
  ds_read_b64_tr_b16 v[198:199], v233 offset:21504
  ds_read_b64_tr_b16 v[200:201], v234 offset:20480
  v_mfma_f32_32x32x16_bf16 v[16:31], v[88:91], v[80:83], 0
  ds_read_b128 v[92:95], v6 offset:28672
  s_waitcnt lgkmcnt(11)
  ds_read_b64_tr_b16 v[202:203], v234 offset:21504
  ds_read_b64_tr_b16 v[204:205], v235 offset:20480
  ds_read_b64_tr_b16 v[206:207], v235 offset:21504
  v_mfma_f32_32x32x16_bf16 v[32:47], v[88:91], v[84:87], 0
  s_nop 9
  s_barrier
  v_exp_f32 v16, v16
  v_exp_f32 v17, v17
  v_exp_f32 v18, v18
  v_exp_f32 v19, v19
  v_exp_f32 v20, v20
  v_exp_f32 v21, v21
  v_exp_f32 v22, v22
  v_exp_f32 v23, v23
  v_exp_f32 v24, v24
  v_exp_f32 v25, v25
  v_exp_f32 v26, v26
  v_exp_f32 v27, v27
  v_exp_f32 v28, v28
  v_exp_f32 v29, v29
  v_exp_f32 v30, v30
  v_exp_f32 v31, v31
  v_exp_f32 v32, v32
  v_exp_f32 v33, v33
  v_exp_f32 v34, v34
  v_exp_f32 v35, v35
  v_exp_f32 v36, v36
  v_exp_f32 v37, v37
  v_exp_f32 v38, v38
  v_exp_f32 v39, v39
  v_exp_f32 v40, v40
  v_exp_f32 v41, v41
  v_exp_f32 v42, v42
  v_exp_f32 v43, v43
  v_exp_f32 v44, v44
  v_exp_f32 v45, v45
  v_exp_f32 v46, v46
  v_exp_f32 v47, v47
  s_setprio 3
  s_waitcnt lgkmcnt(0)
  v_smfmac_f32_32x32x32_bf16 v[48:63], v[96:99], v[16:23], v5
  v_smfmac_f32_32x32x32_bf16 v[48:63], v[100:103], v[24:31], v5
  v_smfmac_f32_32x32x32_bf16 v[64:79], v[100:103], v[40:47], v5
  v_smfmac_f32_32x32x32_bf16 v[64:79], v[96:99], v[32:39], v5
  s_mov_b64 exec, s[52:53]
  ds_read_b128 v[104:107], v7 offset:28672
  ds_read_b128 v[108:111], v7 offset:29184
  s_mov_b64 exec, -1
  v_mfma_f32_32x32x16_bf16 v[16:31], v[92:95], v[80:83], 0
  v_mfma_f32_32x32x16_bf16 v[32:47], v[92:95], v[84:87], 0
  s_nop 9
  s_setprio 0
  v_exp_f32 v16, v16
  s_setprio 2
  v_exp_f32 v17, v17
  v_exp_f32 v18, v18
  v_exp_f32 v19, v19
  v_exp_f32 v20, v20
  v_exp_f32 v21, v21
  v_exp_f32 v22, v22
  v_exp_f32 v23, v23
  v_exp_f32 v24, v24
  v_exp_f32 v25, v25
  v_exp_f32 v26, v26
  v_exp_f32 v27, v27
  v_exp_f32 v28, v28
  v_exp_f32 v29, v29
  s_waitcnt lgkmcnt(1)
  v_smfmac_f32_32x32x32_bf16 v[48:63], v[104:107], v[16:23], v5
  v_exp_f32 v30, v30
  v_exp_f32 v31, v31
  v_exp_f32 v32, v32
  v_exp_f32 v33, v33
  s_waitcnt lgkmcnt(0)
  v_smfmac_f32_32x32x32_bf16 v[48:63], v[108:111], v[24:31], v5
  v_exp_f32 v34, v34
  v_exp_f32 v35, v35
  v_exp_f32 v36, v36
  v_exp_f32 v37, v37
  v_exp_f32 v38, v38
  v_exp_f32 v39, v39
  v_exp_f32 v40, v40
  v_exp_f32 v41, v41
  v_exp_f32 v42, v42
  v_exp_f32 v43, v43
  v_exp_f32 v44, v44
  v_exp_f32 v45, v45
  ds_write_b128 v242, v[48:51] offset:0
  v_exp_f32 v46, v46
  ds_write_b128 v242, v[52:55] offset:1024
  v_exp_f32 v47, v47
  ds_write_b32 v242, v56 offset:2048
  s_setprio 3
  v_smfmac_f32_32x32x32_bf16 v[64:79], v[104:107], v[32:39], v5
  s_waitcnt lgkmcnt(0)
  s_barrier
  ds_read_b32 v24, v243 offset:2048
  ds_read_b128 v[16:19], v243 offset:0
  ds_read_b128 v[20:23], v243 offset:1024
  v_smfmac_f32_32x32x32_bf16 v[64:79], v[108:111], v[40:47], v5
  s_nop 10
  s_waitcnt lgkmcnt(2)
  v_add_f32 v72, v72, v24
  v_rcp_f32 v74, v72
  s_waitcnt lgkmcnt(1)
  v_pk_add_f32 v[64:65], v[64:65], v[16:17]
  v_pk_add_f32 v[66:67], v[66:67], v[18:19]
  s_waitcnt lgkmcnt(0)
  v_pk_add_f32 v[68:69], v[68:69], v[20:21]
  v_pk_add_f32 v[70:71], v[70:71], v[22:23]
  v_pk_add_f32 v[26:27], v[64:65], v[66:67]
  v_pk_mul_f32 v[16:17], v[64:65], v[74:75] op_sel_hi:[1,0]
  v_pk_add_f32 v[28:29], v[68:69], v[70:71]
  v_pk_mul_f32 v[18:19], v[66:67], v[74:75] op_sel_hi:[1,0]
  v_pk_add_f32 v[26:27], v[26:27], v[28:29]
  v_pk_mul_f32 v[20:21], v[68:69], v[74:75] op_sel_hi:[1,0]
  v_add_f32 v26, v26, v27
  v_pk_mul_f32 v[22:23], v[70:71], v[74:75] op_sel_hi:[1,0]
  v_fma_f32 v26, v26, 0, v72
  v_cvt_pk_bf16_f32 v252, v16, v17
  v_subrev_u32 v26, 729808896, v26
  v_cvt_pk_bf16_f32 v253, v18, v19
  v_cmp_lt_u32 vcc, 1006632960, v26
  v_cvt_pk_bf16_f32 v254, v20, v21
  v_cvt_pk_bf16_f32 v255, v22, v23
  v_min_u32 v252, -2, v252
  s_cbranch_vccnz L_fb1
L_fbback1:
  s_mov_b32 s58, 1048576
  s_cmp_lg_u32 s72, 0
  s_cbranch_scc1 L_far_oa1
  buffer_store_dwordx4 v[252:255], v236, s[44:47], s58 offen
L_near_oa1:
  s_setprio 1
  ds_read_b64_tr_b16 v[80:81], v232 offset:24576
  ds_read_b64_tr_b16 v[82:83], v232 offset:25600
  ds_read_b64_tr_b16 v[84:85], v233 offset:24576
  ds_read_b64_tr_b16 v[86:87], v233 offset:25600
  ds_read_b64_tr_b16 v[88:89], v234 offset:24576
  ds_read_b64_tr_b16 v[90:91], v234 offset:25600
  ds_read_b64_tr_b16 v[92:93], v235 offset:24576
  ds_read_b64_tr_b16 v[94:95], v235 offset:25600
  ds_read_b64_tr_b16 v[96:97], v232 offset:28672
  ds_read_b64_tr_b16 v[98:99], v232 offset:29696
  ds_read_b64_tr_b16 v[100:101], v233 offset:28672
  ds_read_b64_tr_b16 v[102:103], v233 offset:29696
  ds_read_b64_tr_b16 v[104:105], v234 offset:28672
  ds_read_b64_tr_b16 v[106:107], v234 offset:29696
  ds_read_b64_tr_b16 v[108:109], v235 offset:28672
  s_waitcnt lgkmcnt(11)
  ds_read_b64_tr_b16 v[110:111], v235 offset:29696
  s_waitcnt vmcnt(0)
  buffer_load_dwordx4 v[16:19], v2, s[44:47], s77 offen sc1
  buffer_load_dwordx4 v[20:23], v2, s[44:47], s77 offen offset:1024 sc1
  buffer_load_dwordx4 v[24:27], v2, s[44:47], s77 offen offset:2048 sc1
  buffer_load_dwordx4 v[28:31], v2, s[44:47], s77 offen offset:3072 sc1
  buffer_load_dwordx4 v[32:35], v2, s[44:47], s8 offen sc1
  buffer_load_dwordx4 v[36:39], v2, s[44:47], s8 offen offset:1024 sc1
  buffer_load_dwordx4 v[40:43], v2, s[44:47], s8 offen offset:2048 sc1
  buffer_load_dwordx4 v[44:47], v2, s[44:47], s8 offen offset:3072 sc1
  buffer_load_dwordx4 v[48:51], v2, s[44:47], s9 offen sc1
  buffer_load_dwordx4 v[52:55], v2, s[44:47], s9 offen offset:1024 sc1
  buffer_load_dwordx4 v[56:59], v2, s[44:47], s9 offen offset:2048 sc1
  buffer_load_dwordx4 v[60:63], v2, s[44:47], s9 offen offset:3072 sc1
  s_waitcnt lgkmcnt(9)
  s_waitcnt vmcnt(8)
  v_max3_u32 v15, v16, v20, v24
  v_max_u32 v15, v15, v28
  v_cmp_eq_u32 vcc, -1, v15
  s_nop 0
  s_cbranch_vccnz L_slow_f1_0
L_back_f1_0:
  v_mfma_f32_16x16x32_bf16 v[208:211], v[112:115], v[16:19], 0
  buffer_load_dwordx4 v[64:67], v2, s[44:47], s10 offen sc1
  v_mfma_f32_16x16x32_bf16 v[212:215], v[116:119], v[16:19], 0
  v_mfma_f32_16x16x32_bf16 v[216:219], v[120:123], v[16:19], 0
  buffer_load_dwordx4 v[68:71], v2, s[44:47], s10 offen offset:1024 sc1
  v_mfma_f32_16x16x32_bf16 v[220:223], v[124:127], v[16:19], 0
  v_mfma_f32_16x16x32_bf16 v[208:211], v[128:131], v[20:23], v[208:211]
  buffer_load_dwordx4 v[72:75], v2, s[44:47], s10 offen offset:2048 sc1
  ds_read_b64_tr_b16 v[112:113], v232 offset:32768
  v_mfma_f32_16x16x32_bf16 v[212:215], v[132:135], v[20:23], v[212:215]
  ds_read_b64_tr_b16 v[114:115], v232 offset:33792
  ds_read_b64_tr_b16 v[116:117], v233 offset:32768
  v_mfma_f32_16x16x32_bf16 v[216:219], v[136:139], v[20:23], v[216:219]
  buffer_load_dwordx4 v[76:79], v2, s[44:47], s10 offen offset:3072 sc1
  ds_read_b64_tr_b16 v[118:119], v233 offset:33792
  v_mfma_f32_16x16x32_bf16 v[220:223], v[140:143], v[20:23], v[220:223]
  ds_read_b64_tr_b16 v[120:121], v234 offset:32768
  ds_read_b64_tr_b16 v[122:123], v234 offset:33792
  s_waitcnt lgkmcnt(9)
  v_mfma_f32_16x16x32_bf16 v[208:211], v[144:147], v[24:27], v[208:211]
  ds_read_b64_tr_b16 v[124:125], v235 offset:32768
  v_mfma_f32_16x16x32_bf16 v[212:215], v[148:151], v[24:27], v[212:215]
  ds_read_b64_tr_b16 v[126:127], v235 offset:33792
  ds_read_b64_tr_b16 v[128:129], v232 offset:36864
  v_mfma_f32_16x16x32_bf16 v[216:219], v[152:155], v[24:27], v[216:219]
  ds_read_b64_tr_b16 v[130:131], v232 offset:37888
  v_mfma_f32_16x16x32_bf16 v[220:223], v[156:159], v[24:27], v[220:223]
  ds_read_b64_tr_b16 v[132:133], v233 offset:36864
  ds_read_b64_tr_b16 v[134:135], v233 offset:37888
  s_waitcnt lgkmcnt(9)
  v_mfma_f32_16x16x32_bf16 v[208:211], v[160:163], v[28:31], v[208:211]
  ds_read_b64_tr_b16 v[136:137], v234 offset:36864
  v_mfma_f32_16x16x32_bf16 v[212:215], v[164:167], v[28:31], v[212:215]
  ds_read_b64_tr_b16 v[138:139], v234 offset:37888
  ds_read_b64_tr_b16 v[140:141], v235 offset:36864
  v_mfma_f32_16x16x32_bf16 v[216:219], v[168:171], v[28:31], v[216:219]
  ds_read_b64_tr_b16 v[142:143], v235 offset:37888
  v_mfma_f32_16x16x32_bf16 v[220:223], v[172:175], v[28:31], v[220:223]
  ds_read_b64_tr_b16 v[144:145], v232 offset:40960
  ds_read_b64_tr_b16 v[146:147], v232 offset:41984
  s_waitcnt lgkmcnt(9)
  s_waitcnt vmcnt(8)
  v_max3_u32 v15, v32, v36, v40
  v_max_u32 v15, v15, v44
  v_cmp_eq_u32 vcc, -1, v15
  s_nop 0
  s_cbranch_vccnz L_slow_f1_1
L_back_f1_1:
  v_mfma_f32_16x16x32_bf16 v[208:211], v[176:179], v[32:35], v[208:211]
  ds_read_b64_tr_b16 v[148:149], v233 offset:40960
  v_mfma_f32_16x16x32_bf16 v[212:215], v[180:183], v[32:35], v[212:215]
  ds_read_b64_tr_b16 v[150:151], v233 offset:41984
  ds_read_b64_tr_b16 v[152:153], v234 offset:40960
  v_mfma_f32_16x16x32_bf16 v[216:219], v[184:187], v[32:35], v[216:219]
  ds_read_b64_tr_b16 v[154:155], v234 offset:41984
  v_mfma_f32_16x16x32_bf16 v[220:223], v[188:191], v[32:35], v[220:223]
  ds_read_b64_tr_b16 v[156:157], v235 offset:40960
  ds_read_b64_tr_b16 v[158:159], v235 offset:41984
  s_waitcnt lgkmcnt(9)
  v_mfma_f32_16x16x32_bf16 v[208:211], v[192:195], v[36:39], v[208:211]
  ds_read_b64_tr_b16 v[160:161], v232 offset:45056
  v_mfma_f32_16x16x32_bf16 v[212:215], v[196:199], v[36:39], v[212:215]
  ds_read_b64_tr_b16 v[162:163], v232 offset:46080
  ds_read_b64_tr_b16 v[164:165], v233 offset:45056
  v_mfma_f32_16x16x32_bf16 v[216:219], v[200:203], v[36:39], v[216:219]
  ds_read_b64_tr_b16 v[166:167], v233 offset:46080
  v_mfma_f32_16x16x32_bf16 v[220:223], v[204:207], v[36:39], v[220:223]
  ds_read_b64_tr_b16 v[168:169], v234 offset:45056
  ds_read_b64_tr_b16 v[170:171], v234 offset:46080
  s_waitcnt lgkmcnt(9)
  v_mfma_f32_16x16x32_bf16 v[208:211], v[80:83], v[40:43], v[208:211]
  ds_read_b64_tr_b16 v[172:173], v235 offset:45056
  v_mfma_f32_16x16x32_bf16 v[212:215], v[84:87], v[40:43], v[212:215]
  ds_read_b64_tr_b16 v[174:175], v235 offset:46080
  ds_read_b64_tr_b16 v[176:177], v232 offset:49152
  v_mfma_f32_16x16x32_bf16 v[216:219], v[88:91], v[40:43], v[216:219]
  ds_read_b64_tr_b16 v[178:179], v232 offset:50176
  v_mfma_f32_16x16x32_bf16 v[220:223], v[92:95], v[40:43], v[220:223]
  ds_read_b64_tr_b16 v[180:181], v233 offset:49152
  ds_read_b64_tr_b16 v[182:183], v233 offset:50176
  s_waitcnt lgkmcnt(9)
  v_mfma_f32_16x16x32_bf16 v[208:211], v[96:99], v[44:47], v[208:211]
  ds_read_b64_tr_b16 v[184:185], v234 offset:49152
  v_mfma_f32_16x16x32_bf16 v[212:215], v[100:103], v[44:47], v[212:215]
  ds_read_b64_tr_b16 v[186:187], v234 offset:50176
  ds_read_b64_tr_b16 v[188:189], v235 offset:49152
  v_mfma_f32_16x16x32_bf16 v[216:219], v[104:107], v[44:47], v[216:219]
  ds_read_b64_tr_b16 v[190:191], v235 offset:50176
  v_mfma_f32_16x16x32_bf16 v[220:223], v[108:111], v[44:47], v[220:223]
  ds_read_b64_tr_b16 v[192:193], v232 offset:53248
  ds_read_b64_tr_b16 v[194:195], v232 offset:54272
  s_waitcnt lgkmcnt(9)
  s_waitcnt vmcnt(4)
  v_max3_u32 v15, v48, v52, v56
  v_max_u32 v15, v15, v60
  v_cmp_eq_u32 vcc, -1, v15
  s_nop 0
  s_cbranch_vccnz L_slow_f1_2
L_back_f1_2:
  v_mfma_f32_16x16x32_bf16 v[208:211], v[112:115], v[48:51], v[208:211]
  ds_read_b64_tr_b16 v[196:197], v233 offset:53248
  v_mfma_f32_16x16x32_bf16 v[212:215], v[116:119], v[48:51], v[212:215]
  ds_read_b64_tr_b16 v[198:199], v233 offset:54272
  ds_read_b64_tr_b16 v[200:201], v234 offset:53248
  v_mfma_f32_16x16x32_bf16 v[216:219], v[120:123], v[48:51], v[216:219]
  ds_read_b64_tr_b16 v[202:203], v234 offset:54272
  v_mfma_f32_16x16x32_bf16 v[220:223], v[124:127], v[48:51], v[220:223]
  ds_read_b64_tr_b16 v[204:205], v235 offset:53248
  ds_read_b64_tr_b16 v[206:207], v235 offset:54272
  s_waitcnt lgkmcnt(9)
  v_mfma_f32_16x16x32_bf16 v[208:211], v[128:131], v[52:55], v[208:211]
  ds_read_b64_tr_b16 v[80:81], v232 offset:57344
  v_mfma_f32_16x16x32_bf16 v[212:215], v[132:135], v[52:55], v[212:215]
  ds_read_b64_tr_b16 v[82:83], v232 offset:58368
  ds_read_b64_tr_b16 v[84:85], v233 offset:57344
  v_mfma_f32_16x16x32_bf16 v[216:219], v[136:139], v[52:55], v[216:219]
  ds_read_b64_tr_b16 v[86:87], v233 offset:58368
  v_mfma_f32_16x16x32_bf16 v[220:223], v[140:143], v[52:55], v[220:223]
  ds_read_b64_tr_b16 v[88:89], v234 offset:57344
  ds_read_b64_tr_b16 v[90:91], v234 offset:58368
  s_waitcnt lgkmcnt(9)
  v_mfma_f32_16x16x32_bf16 v[208:211], v[144:147], v[56:59], v[208:211]
  ds_read_b64_tr_b16 v[92:93], v235 offset:57344
  v_mfma_f32_16x16x32_bf16 v[212:215], v[148:151], v[56:59], v[212:215]
  ds_read_b64_tr_b16 v[94:95], v235 offset:58368
  ds_read_b64_tr_b16 v[96:97], v232 offset:61440
  v_mfma_f32_16x16x32_bf16 v[216:219], v[152:155], v[56:59], v[216:219]
  ds_read_b64_tr_b16 v[98:99], v232 offset:62464
  v_mfma_f32_16x16x32_bf16 v[220:223], v[156:159], v[56:59], v[220:223]
  ds_read_b64_tr_b16 v[100:101], v233 offset:61440
  ds_read_b64_tr_b16 v[102:103], v233 offset:62464
  s_waitcnt lgkmcnt(9)
  v_mfma_f32_16x16x32_bf16 v[208:211], v[160:163], v[60:63], v[208:211]
  ds_read_b64_tr_b16 v[104:105], v234 offset:61440
  v_mfma_f32_16x16x32_bf16 v[212:215], v[164:167], v[60:63], v[212:215]
  ds_read_b64_tr_b16 v[106:107], v234 offset:62464
  ds_read_b64_tr_b16 v[108:109], v235 offset:61440
  v_mfma_f32_16x16x32_bf16 v[216:219], v[168:171], v[60:63], v[216:219]
  ds_read_b64_tr_b16 v[110:111], v235 offset:62464
  v_mfma_f32_16x16x32_bf16 v[220:223], v[172:175], v[60:63], v[220:223]
  s_waitcnt lgkmcnt(9)
  s_waitcnt vmcnt(0)
  v_max3_u32 v15, v64, v68, v72
  v_max_u32 v15, v15, v76
  v_cmp_eq_u32 vcc, -1, v15
  s_nop 0
  s_cbranch_vccnz L_slow_f1_3
L_back_f1_3:
  v_mfma_f32_16x16x32_bf16 v[208:211], v[176:179], v[64:67], v[208:211]
  v_mfma_f32_16x16x32_bf16 v[212:215], v[180:183], v[64:67], v[212:215]
  v_mfma_f32_16x16x32_bf16 v[216:219], v[184:187], v[64:67], v[216:219]
  v_mfma_f32_16x16x32_bf16 v[220:223], v[188:191], v[64:67], v[220:223]
  v_mfma_f32_16x16x32_bf16 v[208:211], v[192:195], v[68:71], v[208:211]
  v_mfma_f32_16x16x32_bf16 v[212:215], v[196:199], v[68:71], v[212:215]
  v_mfma_f32_16x16x32_bf16 v[216:219], v[200:203], v[68:71], v[216:219]
  v_mfma_f32_16x16x32_bf16 v[220:223], v[204:207], v[68:71], v[220:223]
  s_waitcnt lgkmcnt(8)
  v_mfma_f32_16x16x32_bf16 v[208:211], v[80:83], v[72:75], v[208:211]
  v_mfma_f32_16x16x32_bf16 v[212:215], v[84:87], v[72:75], v[212:215]
  v_mfma_f32_16x16x32_bf16 v[216:219], v[88:91], v[72:75], v[216:219]
  v_mfma_f32_16x16x32_bf16 v[220:223], v[92:95], v[72:75], v[220:223]
  s_waitcnt lgkmcnt(0)
  v_mfma_f32_16x16x32_bf16 v[208:211], v[96:99], v[76:79], v[208:211]
  v_mfma_f32_16x16x32_bf16 v[212:215], v[100:103], v[76:79], v[212:215]
  v_mfma_f32_16x16x32_bf16 v[216:219], v[104:107], v[76:79], v[216:219]
  v_mfma_f32_16x16x32_bf16 v[220:223], v[108:111], v[76:79], v[220:223]
  s_nop 4
  v_cvt_pk_bf16_f32 v16, v208, v209
  v_cvt_pk_bf16_f32 v17, v210, v211
  v_cvt_pk_bf16_f32 v18, v212, v213
  v_cvt_pk_bf16_f32 v19, v214, v215
  v_cvt_pk_bf16_f32 v20, v216, v217
  v_cvt_pk_bf16_f32 v21, v218, v219
  v_cvt_pk_bf16_f32 v22, v220, v221
  v_cvt_pk_bf16_f32 v23, v222, v223
  s_nop 1
  v_permlane16_swap_b32 v16, v18
  v_permlane16_swap_b32 v17, v19
  v_permlane16_swap_b32 v20, v22
  v_permlane16_swap_b32 v21, v23
  buffer_store_dwordx4 v[16:19], v237, s[36:39], 0 offen nt
  buffer_store_dwordx4 v[20:23], v237, s[36:39], 0 offen offset:64 nt
  s_endpgm
L_exit:
  s_endpgm
L_codeend:
.section .rodata,"a"
.p2align 6
.amdhsa_kernel concat_heads__grouped_kv_mqa__linear_attn_block__prompt_kernel
  .amdhsa_next_free_vgpr 256
  .amdhsa_next_free_sgpr 102
  .amdhsa_accum_offset 256
  .amdhsa_group_segment_fixed_size 0
  .amdhsa_kernarg_size 88
  .amdhsa_user_sgpr_count 2
  .amdhsa_user_sgpr_kernarg_segment_ptr 1
  .amdhsa_system_sgpr_workgroup_id_x 1
.end_amdhsa_kernel
```
